```python
import torch

def _softmax(x, axis=-1):
    return torch.softmax(x, dim=axis)
def _gelu(x):
    return torch.nn.functional.gelu(x, approximate="tanh")
def _silu(x):
    return torch.nn.functional.silu(x)
def _sigmoid(x):
    return torch.sigmoid(x)
def _layernorm(x, axis=-1, eps=1e-5):
    m = x.mean(dim=axis, keepdim=True)
    v = x.var(dim=axis, keepdim=True, unbiased=False)
    return (x - m) / torch.sqrt(v + eps)
def _scatter_add(tgt, idx, src, axis=0):
    return tgt.clone().index_add_(axis, idx, src)
def _segment_sum(src, seg, n):
    out = torch.zeros((n,) + src.shape[1:], dtype=src.dtype)
    return out.index_add_(0, seg, src)
def _pad(x, pw):
    flat = tuple(v for pair in reversed(pw) for v in pair)
    return torch.nn.functional.pad(x, flat)

kernel_name = 'sequential_preLN__ssm_conv_h3__glu_gated_reglu__prompt'

def setup_inputs():

    _w = (lambda a: (lambda t: t.to(torch.bfloat16) if t.is_floating_point() else t)(torch.as_tensor(a)))
    def _A_setup():
        B, S, D = 1, 2048, 640
        ks = 4
        return {
            "q": _w((lambda *s: torch.randn(*s, dtype=torch.bfloat16) * 0.05)(B, S, D)),
            "k": _w((lambda *s: torch.randn(*s, dtype=torch.bfloat16) * 0.2)(B, S, D)),
            "v": _w((lambda *s: torch.randn(*s, dtype=torch.bfloat16) * 0.2)(B, S, D)),
            "shift_k": _w((lambda *s: torch.randn(*s, dtype=torch.bfloat16) * 0.2)(D, ks) * 0.5),
            "ssm_k": _w((lambda *s: torch.randn(*s, dtype=torch.bfloat16) * 0.4)(D, S) * (1.0 / S ** 0.5)),
            "ssm_D": _w((lambda *s: torch.randn(*s, dtype=torch.bfloat16) * 0.2)(D)),
        }
    _A_in = _A_setup()

    def _B_setup():
        B, S, D, F = 1, 2048, 640, 1536
        return {
            "x": _w((lambda *s: torch.randn(*s, dtype=torch.bfloat16) * 0.05)(B, S, D)),
            "W_gate": _w((lambda *s: torch.randn(*s, dtype=torch.bfloat16) * 0.2)(D, F) * (2.0 / D) ** 0.5),
            "W_up": _w((lambda *s: torch.randn(*s, dtype=torch.bfloat16) * 0.2)(D, F) * (2.0 / D) ** 0.5),
            "W_down": _w((lambda *s: torch.randn(*s, dtype=torch.bfloat16) * 0.2)(F, D) * (1.0 / F) ** 0.5),
        }
    _B_in = _B_setup()

    return {
        "A_q": _A_in["q"],
        "A_k": _A_in["k"],
        "A_v": _A_in["v"],
        "A_shift_k": _A_in["shift_k"],
        "A_ssm_k": _A_in["ssm_k"],
        "A_ssm_D": _A_in["ssm_D"],
        "B_x": _B_in["x"],
        "B_W_gate": _B_in["W_gate"],
        "B_W_up": _B_in["W_up"],
        "B_W_down": _B_in["W_down"],
    }

def reference(A_q, A_k, A_v, A_shift_k, A_ssm_k, A_ssm_D, B_x, B_W_gate, B_W_up, B_W_down):
    def _A_ref(q, k, v, shift_k, ssm_k, ssm_D):
        B, S, D = q.shape
        ks = shift_k.shape[-1]
        k_pad = _pad(k, ((0, 0), (ks - 1, 0), (0, 0)))
        k_shift = torch.zeros_like(k)
        for t in range(ks):
            k_shift = k_shift + k_pad[:, t:t + S, :] * shift_k[:, ks - 1 - t][None, None, :]
        kv = k_shift * v
        L = 2 * S
        kv_pad = _pad(kv, ((0, 0), (0, S), (0, 0)))
        kf_pad = _pad(ssm_k, ((0, 0), (0, S)))
        kv_f = (lambda x, axes=(-2,-1): torch.fft.rfft2(x.float(), dim=axes))(kv_pad[:, None, :, :], axes=(1, 2))
        kf_f = (lambda x, axes=(-2,-1): torch.fft.rfft2(x.float(), dim=axes))(kf_pad[:, None, :], axes=(1, 2))
        kf_f = (lambda x, *d: x.permute(*d))(kf_f, 1, 2, 0)
        y_f = kv_f * kf_f[None, :, :, :]
        y = (lambda x, s, axes=(-2,-1): torch.fft.irfft2(x, s=s, dim=axes).to(torch.bfloat16))(y_f, (1, L), axes=(1, 2))[:, 0, :S, :]
        y = y + kv * ssm_D[None, None, :]
        return q * y

    def _B_ref(x, W_gate, W_up, W_down):
        gate = torch.einsum("bsd,df->bsf", x, W_gate)
        up = torch.einsum("bsd,df->bsf", x, W_up)
        gate = gate * (lambda x, dt: x.to(dt))(gate > 0, gate.dtype)
        h = gate * up
        return torch.einsum("bsf,fd->bsd", h, W_down)

    x = A_q
    h = x + _A_ref(_layernorm(x, axis=-1), A_k, A_v, A_shift_k, A_ssm_k, A_ssm_D)
    h2 = h + _B_ref(_layernorm(h, axis=-1), B_W_gate, B_W_up, B_W_down)
    return h2
```

```asm
; @launch grid=(256,1,1) block=(512,1,1) lds=154432
.amdgcn_target "amdgcn-amd-amdhsa--gfx950"
.text
.p2align 8
.globl sequential_preLN__ssm_conv_h3__glu_gated_reglu__prompt_kernel
.type sequential_preLN__ssm_conv_h3__glu_gated_reglu__prompt_kernel,@function
sequential_preLN__ssm_conv_h3__glu_gated_reglu__prompt_kernel:
    s_cmp_ge_u32 s2, 256
    s_cbranch_scc1 M_END
    s_load_dwordx16 s[64:79], s[0:1], 0
    s_load_dwordx8 s[80:87], s[0:1], 64
    s_load_dwordx2 s[88:89], s[0:1], 96
    v_lshrrev_b32 v1, 6, v0
    v_and_b32 v0, 63, v0
    v_readfirstlane_b32 s3, v1
    s_mov_b32 s40, 0xffff0000
    s_mov_b32 s43, 0x3f803f80
    s_mov_b32 s94, 20971520
    s_mov_b32 s95, 0x20000
    s_mov_b32 s98, 256
    s_mov_b32 s99, 0x20000
    s_and_b32 s5, s3, 3
    s_lshr_b32 s6, s2, 5
    s_and_b32 s7, s6, 1
    s_lshl_b32 s7, s7, 2
    s_add_u32 s7, s7, s2
    s_and_b32 s7, s7, 31
    s_mul_i32 s8, s6, 20
    s_add_u32 s8, s8, s7
    s_mul_i32 s9, s6, 12
    s_add_u32 s9, s9, s7
    s_add_u32 s9, s9, 140
    s_cmp_lt_u32 s7, 20
    s_cselect_b32 s90, s8, s9

    v_and_b32 v6, 3, v0
    v_lshrrev_b32 v7, 2, v0
    s_and_b32 s38, s2, 31
    s_lshl_b32 s38, s38, 6
    s_lshr_b32 s39, s2, 5
    s_mul_i32 s39, s39, 80
    s_lshl_b32 s27, s5, 5
    s_add_u32 s39, s39, s27
    s_mul_i32 s26, s3, 4608
    s_add_u32 s26, s26, 104448
    s_cmp_ge_u32 s3, 4
    s_cselect_b32 s27, 4608, 0
    s_sub_u32 s26, s26, s27
    v_mul_u32_u24 v5, 1152, v6
    v_add_u32 v5, s26, v5
    s_mov_b32 s15, s26
    v_lshl_add_u32 v4, v7, 2, s38
    v_mul_u32_u24 v1, 1280, v4
    v_lshl_add_u32 v188, s5, 2, v6
    v_cmp_gt_u32 vcc, 10, v188
    v_lshl_add_u32 v6, v6, 3, s39
    v_lshl_add_u32 v1, v6, 1, v1
    v_mov_b32 v4, 0x80000000
    v_cndmask_b32 v1, v4, v1, vcc
    v_lshrrev_b32 v4, 4, v0
    v_lshl_add_u32 v188, s5, 2, v4
    v_cmp_gt_u32 vcc, 10, v188
    v_bfe_u32 v188, v0, 3, 1
    v_lshl_add_u32 v4, v4, 3, v188
    v_mul_u32_u24 v189, 144, v4
    v_add_u32 v4, s39, v4
    v_lshlrev_b32 v4, 12, v4
    v_and_b32 v188, 7, v0
    v_lshl_add_u32 v4, v188, 4, v4
    v_lshl_add_u32 v189, v188, 4, v189
    v_add_u32 v189, s26, v189
    v_mov_b32 v188, 0x80000000
    v_cndmask_b32 v4, v188, v4, vcc

    s_cmp_ge_u32 s3, 4
    s_cbranch_scc1 M_UPPER

    v_add_u32 v2, -3840, v1
    v_lshlrev_b32 v3, 3, v6
    s_lshl_b32 s28, s90, 2
    s_add_u32 s28, s28, s3
    s_cmp_lt_u32 s90, 160
    s_cselect_b32 s28, s28, 0
    s_cselect_b32 s18, 4096, 0
    s_lshl_b32 s29, s28, 12
    v_lshlrev_b32 v190, 4, v0
    v_add_u32 v191, -8, v190
    v_add_u32 v192, 1016, v190
    s_waitcnt lgkmcnt(0)

    s_mov_b32 s20, s66
    s_mov_b32 s21, s67
    s_mov_b32 s22, 2621440
    s_mov_b32 s23, 0x20000
    s_mov_b32 s24, s68
    s_mov_b32 s25, s69
    s_mov_b32 s26, 2621440
    s_mov_b32 s27, 0x20000
    s_mov_b32 s32, s70
    s_mov_b32 s33, s71
    s_mov_b32 s34, 5120
    s_mov_b32 s35, 0x20000
    s_cmp_eq_u32 s3, 3
    s_cbranch_scc1 M_NOKVL
    buffer_load_dwordx4 v[20:23], v1, s[20:23], 0 offen offset:0
    buffer_load_dwordx4 v[24:27], v1, s[20:23], 0 offen offset:1280
    buffer_load_dwordx4 v[28:31], v1, s[20:23], 0 offen offset:2560
    buffer_load_dwordx4 v[32:35], v1, s[20:23], 0 offen offset:3840
    buffer_load_dwordx4 v[36:39], v1, s[24:27], 0 offen offset:0
    buffer_load_dwordx4 v[40:43], v1, s[24:27], 0 offen offset:1280
    buffer_load_dwordx4 v[44:47], v1, s[24:27], 0 offen offset:2560
    buffer_load_dwordx4 v[48:51], v1, s[24:27], 0 offen offset:3840
    buffer_load_dwordx4 v[8:11], v2, s[20:23], 0 offen offset:0
    buffer_load_dwordx4 v[12:15], v2, s[20:23], 0 offen offset:1280
    buffer_load_dwordx4 v[16:19], v2, s[20:23], 0 offen offset:2560
    buffer_load_dwordx4 v[68:71], v3, s[32:35], 0 offen offset:0
    buffer_load_dwordx4 v[72:75], v3, s[32:35], 0 offen offset:16
    buffer_load_dwordx4 v[76:79], v3, s[32:35], 0 offen offset:32
    buffer_load_dwordx4 v[80:83], v3, s[32:35], 0 offen offset:48
M_NOKVL:
    s_add_u32 s16, s72, s29
    s_addc_u32 s17, s73, 0
    s_mov_b32 s19, 0x20000
    s_mov_b32 s92, s88
    s_mov_b32 s93, s89
    s_mov_b32 s96, s86
    s_mov_b32 s97, s87
    s_lshl_b32 s8, s2, 7
    s_add_u32 s8, s8, 8347648
    s_lshl_b32 s9, s6, 7
    s_add_u32 s9, s9, 8380416
    s_and_b32 s10, s2, 31
    s_cmp_eq_u32 s10, 0
    s_mov_b32 s9, 0x40000000
    v_mov_b32 v198, s8
    v_mov_b32 v199, s9
    v_cmp_eq_u32 vcc, 0, v0
    v_mov_b32 v194, 0
    v_mov_b32 v195, 0
    v_mov_b32 v196, 0
    v_mov_b32 v197, 0
    v_cndmask_b32 v198, v199, v198, vcc
    s_cmp_eq_u32 s3, 3
    s_cbranch_scc0 M_NOZ
    s_mov_b64 exec, 1
    buffer_store_dwordx4 v[194:197], v198, s[92:95], 0 offen sc1
    s_mov_b64 exec, -1
M_NOZ:

    v_sub_u32 v7, 15, v7
    v_lshl_add_u32 v5, v7, 3, v5
    s_sub_u32 s31, 1984, s38
    s_lshl_b32 s31, s31, 1
    s_and_b32 s36, s28, 0xfffffffe
    s_lshl_b32 s36, s36, 1
    s_load_dword s37, s[74:75], s36
    s_mul_i32 s30, s3, 26112
    v_add_u32 v193, s30, v190
    v_mov_b32 v194, 0
    v_mov_b32 v195, 0
    v_mov_b32 v196, 0
    v_mov_b32 v197, 0
    s_mov_b64 exec, 7

    ds_write_b128 v193, v[194:197] offset:0
    ds_write_b128 v193, v[194:197] offset:4160
    ds_write_b128 v193, v[194:197] offset:8320
    ds_write_b128 v193, v[194:197] offset:12480
    s_mov_b64 exec, 0xfffffff
    ds_write_b128 v193, v[194:197] offset:20736
    ds_write_b128 v193, v[194:197] offset:25376
    s_mov_b64 exec, -1
    v_mov_b32 v198, 153344
    ds_write_b128 v198, v[194:197]
    ds_write_b128 v198, v[194:197] offset:16
    ds_write_b128 v198, v[194:197] offset:32
    ds_write_b128 v198, v[194:197] offset:48
    s_waitcnt lgkmcnt(0)
    s_barrier
    s_waitcnt vmcnt(0)

    v_mov_b32 v246, 153364
    v_mov_b32 v247, 1
    s_mov_b64 exec, 1
    ds_add_u32 v246, v247
    s_mov_b64 exec, -1

    s_cmp_eq_u32 s3, 3
    s_cbranch_scc1 M_SKIPKV
    v_lshlrev_b32 v106, 16, v68
    v_lshlrev_b32 v107, 16, v70
    v_and_b32 v108, s40, v68
    v_and_b32 v109, s40, v70
    v_lshlrev_b32 v110, 16, v69
    v_lshlrev_b32 v111, 16, v71
    v_and_b32 v112, s40, v69
    v_and_b32 v113, s40, v71

    v_lshlrev_b32 v84, 16, v8
    v_and_b32 v85, s40, v8
    v_lshlrev_b32 v86, 16, v12
    v_and_b32 v87, s40, v12
    v_lshlrev_b32 v88, 16, v16
    v_and_b32 v89, s40, v16
    v_lshlrev_b32 v90, 16, v20
    v_and_b32 v91, s40, v20
    v_lshlrev_b32 v92, 16, v24
    v_and_b32 v93, s40, v24
    v_lshlrev_b32 v94, 16, v28
    v_and_b32 v95, s40, v28
    v_lshlrev_b32 v96, 16, v32
    v_and_b32 v97, s40, v32
    v_lshlrev_b32 v98, 16, v36
    v_and_b32 v99, s40, v36
    v_lshlrev_b32 v100, 16, v40
    v_and_b32 v101, s40, v40
    v_lshlrev_b32 v102, 16, v44
    v_and_b32 v103, s40, v44
    v_lshlrev_b32 v104, 16, v48
    v_and_b32 v105, s40, v48
    v_pk_mul_f32 v[114:115], v[90:91], v[106:107]
    v_pk_fma_f32 v[114:115], v[88:89], v[108:109], v[114:115]
    v_pk_fma_f32 v[114:115], v[86:87], v[110:111], v[114:115]
    v_pk_fma_f32 v[114:115], v[84:85], v[112:113], v[114:115]
    v_pk_mul_f32 v[116:117], v[92:93], v[106:107]
    v_pk_fma_f32 v[116:117], v[90:91], v[108:109], v[116:117]
    v_pk_fma_f32 v[116:117], v[88:89], v[110:111], v[116:117]
    v_pk_fma_f32 v[116:117], v[86:87], v[112:113], v[116:117]
    v_pk_mul_f32 v[118:119], v[94:95], v[106:107]
    v_pk_fma_f32 v[118:119], v[92:93], v[108:109], v[118:119]
    v_pk_fma_f32 v[118:119], v[90:91], v[110:111], v[118:119]
    v_pk_fma_f32 v[118:119], v[88:89], v[112:113], v[118:119]
    v_pk_mul_f32 v[120:121], v[96:97], v[106:107]
    v_pk_fma_f32 v[120:121], v[94:95], v[108:109], v[120:121]
    v_pk_fma_f32 v[120:121], v[92:93], v[110:111], v[120:121]
    v_pk_fma_f32 v[120:121], v[90:91], v[112:113], v[120:121]
    v_pk_mul_f32 v[114:115], v[114:115], v[98:99]
    v_pk_mul_f32 v[116:117], v[116:117], v[100:101]
    v_pk_mul_f32 v[118:119], v[118:119], v[102:103]
    v_pk_mul_f32 v[120:121], v[120:121], v[104:105]
    v_cvt_pk_bf16_f32 v144, v120, v118
    v_cvt_pk_bf16_f32 v145, v116, v114
    ds_write_b64 v5, v[144:145] offset:0
    v_cvt_pk_bf16_f32 v146, v121, v119
    v_cvt_pk_bf16_f32 v147, v117, v115
    ds_write_b64 v5, v[146:147] offset:144
    ds_read_b128 v[160:163], v189 offset:0
    v_lshlrev_b32 v106, 16, v72
    v_lshlrev_b32 v107, 16, v74
    v_and_b32 v108, s40, v72
    v_and_b32 v109, s40, v74
    v_lshlrev_b32 v110, 16, v73
    v_lshlrev_b32 v111, 16, v75
    v_and_b32 v112, s40, v73
    v_and_b32 v113, s40, v75

    v_lshlrev_b32 v84, 16, v9
    v_and_b32 v85, s40, v9
    v_lshlrev_b32 v86, 16, v13
    v_and_b32 v87, s40, v13
    v_lshlrev_b32 v88, 16, v17
    v_and_b32 v89, s40, v17
    v_lshlrev_b32 v90, 16, v21
    v_and_b32 v91, s40, v21
    v_lshlrev_b32 v92, 16, v25
    v_and_b32 v93, s40, v25
    v_lshlrev_b32 v94, 16, v29
    v_and_b32 v95, s40, v29
    v_lshlrev_b32 v96, 16, v33
    v_and_b32 v97, s40, v33
    v_lshlrev_b32 v98, 16, v37
    v_and_b32 v99, s40, v37
    v_lshlrev_b32 v100, 16, v41
    v_and_b32 v101, s40, v41
    v_lshlrev_b32 v102, 16, v45
    v_and_b32 v103, s40, v45
    v_lshlrev_b32 v104, 16, v49
    v_and_b32 v105, s40, v49
    s_add_u32 s41, s31, 0
    s_waitcnt lgkmcnt(0)
    buffer_store_dwordx4 v[160:163], v4, s[92:95], s41 offen sc1

    v_pk_mul_f32 v[114:115], v[90:91], v[106:107]
    v_pk_fma_f32 v[114:115], v[88:89], v[108:109], v[114:115]
    v_pk_fma_f32 v[114:115], v[86:87], v[110:111], v[114:115]
    v_pk_fma_f32 v[114:115], v[84:85], v[112:113], v[114:115]
    v_pk_mul_f32 v[116:117], v[92:93], v[106:107]
    v_pk_fma_f32 v[116:117], v[90:91], v[108:109], v[116:117]
    v_pk_fma_f32 v[116:117], v[88:89], v[110:111], v[116:117]
    v_pk_fma_f32 v[116:117], v[86:87], v[112:113], v[116:117]
    v_pk_mul_f32 v[118:119], v[94:95], v[106:107]
    v_pk_fma_f32 v[118:119], v[92:93], v[108:109], v[118:119]
    v_pk_fma_f32 v[118:119], v[90:91], v[110:111], v[118:119]
    v_pk_fma_f32 v[118:119], v[88:89], v[112:113], v[118:119]
    v_pk_mul_f32 v[120:121], v[96:97], v[106:107]
    v_pk_fma_f32 v[120:121], v[94:95], v[108:109], v[120:121]
    v_pk_fma_f32 v[120:121], v[92:93], v[110:111], v[120:121]
    v_pk_fma_f32 v[120:121], v[90:91], v[112:113], v[120:121]
    v_pk_mul_f32 v[114:115], v[114:115], v[98:99]
    v_pk_mul_f32 v[116:117], v[116:117], v[100:101]
    v_pk_mul_f32 v[118:119], v[118:119], v[102:103]
    v_pk_mul_f32 v[120:121], v[120:121], v[104:105]
    v_cvt_pk_bf16_f32 v148, v120, v118
    v_cvt_pk_bf16_f32 v149, v116, v114
    ds_write_b64 v5, v[148:149] offset:288
    v_cvt_pk_bf16_f32 v150, v121, v119
    v_cvt_pk_bf16_f32 v151, v117, v115
    ds_write_b64 v5, v[150:151] offset:432
    ds_read_b128 v[164:167], v189 offset:288
    v_lshlrev_b32 v106, 16, v76
    v_lshlrev_b32 v107, 16, v78
    v_and_b32 v108, s40, v76
    v_and_b32 v109, s40, v78
    v_lshlrev_b32 v110, 16, v77
    v_lshlrev_b32 v111, 16, v79
    v_and_b32 v112, s40, v77
    v_and_b32 v113, s40, v79

    v_lshlrev_b32 v84, 16, v10
    v_and_b32 v85, s40, v10
    v_lshlrev_b32 v86, 16, v14
    v_and_b32 v87, s40, v14
    v_lshlrev_b32 v88, 16, v18
    v_and_b32 v89, s40, v18
    v_lshlrev_b32 v90, 16, v22
    v_and_b32 v91, s40, v22
    v_lshlrev_b32 v92, 16, v26
    v_and_b32 v93, s40, v26
    v_lshlrev_b32 v94, 16, v30
    v_and_b32 v95, s40, v30
    v_lshlrev_b32 v96, 16, v34
    v_and_b32 v97, s40, v34
    v_lshlrev_b32 v98, 16, v38
    v_and_b32 v99, s40, v38
    v_lshlrev_b32 v100, 16, v42
    v_and_b32 v101, s40, v42
    v_lshlrev_b32 v102, 16, v46
    v_and_b32 v103, s40, v46
    v_lshlrev_b32 v104, 16, v50
    v_and_b32 v105, s40, v50
    s_add_u32 s41, s31, 8192
    s_waitcnt lgkmcnt(0)
    buffer_store_dwordx4 v[164:167], v4, s[92:95], s41 offen sc1

    v_pk_mul_f32 v[114:115], v[90:91], v[106:107]
    v_pk_fma_f32 v[114:115], v[88:89], v[108:109], v[114:115]
    v_pk_fma_f32 v[114:115], v[86:87], v[110:111], v[114:115]
    v_pk_fma_f32 v[114:115], v[84:85], v[112:113], v[114:115]
    v_pk_mul_f32 v[116:117], v[92:93], v[106:107]
    v_pk_fma_f32 v[116:117], v[90:91], v[108:109], v[116:117]
    v_pk_fma_f32 v[116:117], v[88:89], v[110:111], v[116:117]
    v_pk_fma_f32 v[116:117], v[86:87], v[112:113], v[116:117]
    v_pk_mul_f32 v[118:119], v[94:95], v[106:107]
    v_pk_fma_f32 v[118:119], v[92:93], v[108:109], v[118:119]
    v_pk_fma_f32 v[118:119], v[90:91], v[110:111], v[118:119]
    v_pk_fma_f32 v[118:119], v[88:89], v[112:113], v[118:119]
    v_pk_mul_f32 v[120:121], v[96:97], v[106:107]
    v_pk_fma_f32 v[120:121], v[94:95], v[108:109], v[120:121]
    v_pk_fma_f32 v[120:121], v[92:93], v[110:111], v[120:121]
    v_pk_fma_f32 v[120:121], v[90:91], v[112:113], v[120:121]
    v_pk_mul_f32 v[114:115], v[114:115], v[98:99]
    v_pk_mul_f32 v[116:117], v[116:117], v[100:101]
    v_pk_mul_f32 v[118:119], v[118:119], v[102:103]
    v_pk_mul_f32 v[120:121], v[120:121], v[104:105]
    v_cvt_pk_bf16_f32 v152, v120, v118
    v_cvt_pk_bf16_f32 v153, v116, v114
    ds_write_b64 v5, v[152:153] offset:576
    v_cvt_pk_bf16_f32 v154, v121, v119
    v_cvt_pk_bf16_f32 v155, v117, v115
    ds_write_b64 v5, v[154:155] offset:720
    ds_read_b128 v[168:171], v189 offset:576
    v_lshlrev_b32 v106, 16, v80
    v_lshlrev_b32 v107, 16, v82
    v_and_b32 v108, s40, v80
    v_and_b32 v109, s40, v82
    v_lshlrev_b32 v110, 16, v81
    v_lshlrev_b32 v111, 16, v83
    v_and_b32 v112, s40, v81
    v_and_b32 v113, s40, v83

    v_lshlrev_b32 v84, 16, v11
    v_and_b32 v85, s40, v11
    v_lshlrev_b32 v86, 16, v15
    v_and_b32 v87, s40, v15
    v_lshlrev_b32 v88, 16, v19
    v_and_b32 v89, s40, v19
    v_lshlrev_b32 v90, 16, v23
    v_and_b32 v91, s40, v23
    v_lshlrev_b32 v92, 16, v27
    v_and_b32 v93, s40, v27
    v_lshlrev_b32 v94, 16, v31
    v_and_b32 v95, s40, v31
    v_lshlrev_b32 v96, 16, v35
    v_and_b32 v97, s40, v35
    v_lshlrev_b32 v98, 16, v39
    v_and_b32 v99, s40, v39
    v_lshlrev_b32 v100, 16, v43
    v_and_b32 v101, s40, v43
    v_lshlrev_b32 v102, 16, v47
    v_and_b32 v103, s40, v47
    v_lshlrev_b32 v104, 16, v51
    v_and_b32 v105, s40, v51
    s_add_u32 s41, s31, 16384
    s_waitcnt lgkmcnt(0)
    buffer_store_dwordx4 v[168:171], v4, s[92:95], s41 offen sc1

    v_pk_mul_f32 v[114:115], v[90:91], v[106:107]
    v_pk_fma_f32 v[114:115], v[88:89], v[108:109], v[114:115]
    v_pk_fma_f32 v[114:115], v[86:87], v[110:111], v[114:115]
    v_pk_fma_f32 v[114:115], v[84:85], v[112:113], v[114:115]
    v_pk_mul_f32 v[116:117], v[92:93], v[106:107]
    v_pk_fma_f32 v[116:117], v[90:91], v[108:109], v[116:117]
    v_pk_fma_f32 v[116:117], v[88:89], v[110:111], v[116:117]
    v_pk_fma_f32 v[116:117], v[86:87], v[112:113], v[116:117]
    v_pk_mul_f32 v[118:119], v[94:95], v[106:107]
    v_pk_fma_f32 v[118:119], v[92:93], v[108:109], v[118:119]
    v_pk_fma_f32 v[118:119], v[90:91], v[110:111], v[118:119]
    v_pk_fma_f32 v[118:119], v[88:89], v[112:113], v[118:119]
    v_pk_mul_f32 v[120:121], v[96:97], v[106:107]
    v_pk_fma_f32 v[120:121], v[94:95], v[108:109], v[120:121]
    v_pk_fma_f32 v[120:121], v[92:93], v[110:111], v[120:121]
    v_pk_fma_f32 v[120:121], v[90:91], v[112:113], v[120:121]
    v_pk_mul_f32 v[114:115], v[114:115], v[98:99]
    v_pk_mul_f32 v[116:117], v[116:117], v[100:101]
    v_pk_mul_f32 v[118:119], v[118:119], v[102:103]
    v_pk_mul_f32 v[120:121], v[120:121], v[104:105]
    v_cvt_pk_bf16_f32 v156, v120, v118
    v_cvt_pk_bf16_f32 v157, v116, v114
    ds_write_b64 v5, v[156:157] offset:864
    v_cvt_pk_bf16_f32 v158, v121, v119
    v_cvt_pk_bf16_f32 v159, v117, v115
    ds_write_b64 v5, v[158:159] offset:1008
    ds_read_b128 v[172:175], v189 offset:864
    s_add_u32 s41, s31, 24576
    s_waitcnt lgkmcnt(0)
    buffer_store_dwordx4 v[172:175], v4, s[92:95], s41 offen sc1

    buffer_load_dwordx4 v[202:205], v190, s[16:19], 0 offen offset:0
    buffer_load_dwordx2 v[200:201], v191, s[16:19], 0 offen
    buffer_load_dwordx4 v[208:211], v190, s[16:19], 0 offen offset:1024
    buffer_load_dwordx2 v[206:207], v192, s[16:19], 0 offen offset:0
    buffer_load_dwordx4 v[214:217], v190, s[16:19], 0 offen offset:2048
    buffer_load_dwordx2 v[212:213], v192, s[16:19], 0 offen offset:1024
    buffer_load_dwordx4 v[220:223], v190, s[16:19], 0 offen offset:3072
    buffer_load_dwordx2 v[218:219], v192, s[16:19], 0 offen offset:2048
    s_waitcnt vmcnt(8)
    v_mov_b32 v246, 153344
    v_mov_b32 v247, 1
    s_mov_b64 exec, 1
    ds_add_u32 v246, v247
    s_mov_b64 exec, -1

    s_branch M_KVDONE
M_SKIPKV:
    buffer_load_dwordx4 v[202:205], v190, s[16:19], 0 offen offset:0
    buffer_load_dwordx2 v[200:201], v191, s[16:19], 0 offen
    buffer_load_dwordx4 v[208:211], v190, s[16:19], 0 offen offset:1024
    buffer_load_dwordx2 v[206:207], v192, s[16:19], 0 offen offset:0
    buffer_load_dwordx4 v[214:217], v190, s[16:19], 0 offen offset:2048
    buffer_load_dwordx2 v[212:213], v192, s[16:19], 0 offen offset:1024
    buffer_load_dwordx4 v[220:223], v190, s[16:19], 0 offen offset:3072
    buffer_load_dwordx2 v[218:219], v192, s[16:19], 0 offen offset:2048
M_KVDONE:
    s_cmp_ge_u32 s90, 160
    s_cbranch_scc1 M_LOWNC

    s_waitcnt vmcnt(6)
    ds_write_b128 v193, v[202:205] offset:12528
    v_alignbit_b32 v80, v201, v200, 16
    v_alignbit_b32 v81, v202, v201, 16
    v_alignbit_b32 v82, v203, v202, 16
    v_alignbit_b32 v83, v204, v203, 16
    ds_write_b128 v193, v[80:83] offset:48
    v_alignbit_b32 v84, v202, v201, 16
    v_alignbit_b32 v85, v203, v202, 16
    v_alignbit_b32 v86, v204, v203, 16
    v_alignbit_b32 v87, v205, v204, 16
    ds_write_b128 v193, v[84:87] offset:8368
    v_mov_b32 v88, v201
    v_mov_b32 v89, v202
    v_mov_b32 v90, v203
    v_mov_b32 v91, v204
    ds_write_b128 v193, v[88:91] offset:4208
    s_waitcnt vmcnt(4)
    ds_write_b128 v193, v[208:211] offset:13552
    v_alignbit_b32 v92, v207, v206, 16
    v_alignbit_b32 v93, v208, v207, 16
    v_alignbit_b32 v94, v209, v208, 16
    v_alignbit_b32 v95, v210, v209, 16
    ds_write_b128 v193, v[92:95] offset:1072
    v_alignbit_b32 v96, v208, v207, 16
    v_alignbit_b32 v97, v209, v208, 16
    v_alignbit_b32 v98, v210, v209, 16
    v_alignbit_b32 v99, v211, v210, 16
    ds_write_b128 v193, v[96:99] offset:9392
    v_mov_b32 v100, v207
    v_mov_b32 v101, v208
    v_mov_b32 v102, v209
    v_mov_b32 v103, v210
    ds_write_b128 v193, v[100:103] offset:5232
    s_waitcnt vmcnt(2)
    ds_write_b128 v193, v[214:217] offset:14576
    v_alignbit_b32 v80, v213, v212, 16
    v_alignbit_b32 v81, v214, v213, 16
    v_alignbit_b32 v82, v215, v214, 16
    v_alignbit_b32 v83, v216, v215, 16
    ds_write_b128 v193, v[80:83] offset:2096
    v_alignbit_b32 v84, v214, v213, 16
    v_alignbit_b32 v85, v215, v214, 16
    v_alignbit_b32 v86, v216, v215, 16
    v_alignbit_b32 v87, v217, v216, 16
    ds_write_b128 v193, v[84:87] offset:10416
    v_mov_b32 v88, v213
    v_mov_b32 v89, v214
    v_mov_b32 v90, v215
    v_mov_b32 v91, v216
    ds_write_b128 v193, v[88:91] offset:6256
    s_waitcnt vmcnt(0)
    ds_write_b128 v193, v[220:223] offset:15600
    v_alignbit_b32 v92, v219, v218, 16
    v_alignbit_b32 v93, v220, v219, 16
    v_alignbit_b32 v94, v221, v220, 16
    v_alignbit_b32 v95, v222, v221, 16
    ds_write_b128 v193, v[92:95] offset:3120
    v_alignbit_b32 v96, v220, v219, 16
    v_alignbit_b32 v97, v221, v220, 16
    v_alignbit_b32 v98, v222, v221, 16
    v_alignbit_b32 v99, v223, v222, 16
    ds_write_b128 v193, v[96:99] offset:11440
    v_mov_b32 v100, v219
    v_mov_b32 v101, v220
    v_mov_b32 v102, v221
    v_mov_b32 v103, v222
    ds_write_b128 v193, v[100:103] offset:7280
    v_mov_b32 v1, v190
    v_and_b32 v2, 15, v0
    v_lshrrev_b32 v3, 4, v0
    v_add_u32 v6, 8, v1
    v_and_b32 v8, 1, v2
    v_lshlrev_b32 v8, 2, v8
    v_lshrrev_b32 v9, 1, v2
    v_lshl_add_u32 v8, v9, 5, v8
    v_lshl_add_u32 v8, v3, 3, v8
    v_lshlrev_b32 v12, 1, v8
    v_lshlrev_b32 v13, 2, v8
    v_add_u32 v13, 104448, v13
    s_lshl_b32 s31, s3, 12
    s_add_u32 s31, s31, 120832
    v_add_u32 v7, s31, v12
    v_and_b32 v9, 3, v2
    v_mul_u32_u24 v9, 4160, v9
    v_lshrrev_b32 v10, 2, v2
    v_add_u32 v10, v10, v3
    v_lshl_add_u32 v14, v10, 4, v9
    v_add_u32 v14, s30, v14
    v_and_b32 v9, 1, v2
    v_mul_u32_u24 v9, 4640, v9
    v_lshrrev_b32 v10, 1, v2
    v_lshlrev_b32 v10, 2, v10
    v_sub_u32 v10, v3, v10
    v_add_u32 v10, 28, v10
    v_lshl_add_u32 v15, v10, 4, v9
    s_add_u32 s32, s30, 16640
    v_add_u32 v15, s32, v15
    v_sub_u32 v11, 252, v8
    v_lshlrev_b32 v11, 1, v11
    s_add_u32 s32, s30, 21280
    v_add_u32 v11, s32, v11
    s_add_u32 s20, s88, s29
    s_addc_u32 s21, s89, 0
    s_mov_b32 s22, 4096
    s_mov_b32 s23, 0x20000
    s_mul_i32 s41, s28, 4096
    s_add_u32 s41, s41, 8388608
    s_add_u32 m0, s30, 21280

    v_mov_b32 v16, 0
    v_mov_b32 v17, 0
    v_mov_b32 v18, 0
    v_mov_b32 v19, 0
    v_mov_b32 v20, 0
    v_mov_b32 v21, 0
    v_mov_b32 v22, 0
    v_mov_b32 v23, 0
    v_mov_b32 v24, 0
    v_mov_b32 v25, 0
    v_mov_b32 v26, 0
    v_mov_b32 v27, 0
    v_mov_b32 v28, 0
    v_mov_b32 v29, 0
    v_mov_b32 v30, 0
    v_mov_b32 v31, 0
    v_mov_b32 v32, 0
    v_mov_b32 v33, 0
    v_mov_b32 v34, 0
    v_mov_b32 v35, 0
    v_mov_b32 v36, 0
    v_mov_b32 v37, 0
    v_mov_b32 v38, 0
    v_mov_b32 v39, 0
    v_mov_b32 v40, 0
    v_mov_b32 v41, 0
    v_mov_b32 v42, 0
    v_mov_b32 v43, 0
    v_mov_b32 v44, 0
    v_mov_b32 v45, 0
    v_mov_b32 v46, 0
    v_mov_b32 v47, 0
    s_waitcnt lgkmcnt(0)
    ds_read_b128 v[48:51], v14 offset:0
    ds_read_b128 v[52:55], v14 offset:512
    ds_read_b128 v[56:59], v14 offset:1024
    ds_read_b128 v[60:63], v14 offset:1536
    ds_read_b128 v[64:67], v14 offset:2048
    ds_read_b128 v[68:71], v14 offset:2560
    ds_read_b128 v[72:75], v14 offset:3072
    ds_read_b128 v[76:79], v14 offset:3584
    s_cmp_lg_u32 s3, 3
    s_cbranch_scc1 M_NOS1
    v_mov_b32 v246, 153344
    s_mov_b32 s4, 0
LW_1:
    ds_read_b32 v247, v246
    s_add_u32 s4, s4, 1
    s_waitcnt lgkmcnt(0)
    v_cmp_gt_u32 vcc, 7, v247
    s_cmp_gt_u32 s4, 0x400000
    s_cbranch_scc1 LW_1_x
    s_cbranch_vccnz LW_1
LW_1_x:

    s_lshr_b32 s38, s2, 5
    s_lshl_b32 s39, s38, 12
    s_add_u32 s39, s39, 8347648
    s_and_b32 s4, s38, 3
    s_lshl_b32 s4, s4, 6
    s_lshr_b32 s38, s38, 2
    s_lshl_b32 s38, s38, 4
    s_add_u32 s38, s38, s4

    v_mov_b32 v248, s38
    v_mov_b32 v249, 1
    s_mov_b64 exec, 1
    buffer_atomic_add v249, v248, s[96:99], 0 offen sc0 sc1
    s_waitcnt vmcnt(0)
    v_readfirstlane_b32 s4, v249
    s_mov_b64 exec, -1
    s_and_b32 s4, s4, 31
    s_cmp_lg_u32 s4, 31
    s_cbranch_scc1 ARR_2

    v_mov_b32 v251, 1
    v_lshlrev_b32 v250, 7, v0
    v_add_u32 v250, s39, v250

    s_mov_b64 exec, 0x7fffffff
    s_bitset1_b64 exec, 31
    buffer_store_dword v251, v250, s[92:95], 0 offen sc1
    s_mov_b64 exec, -1
    v_mov_b32 v246, 153396
    v_mov_b32 v247, 1
    ds_write_b32 v246, v247

    s_branch ARR_2_d
ARR_2:
    s_lshl_b32 s4, s2, 7
    s_add_u32 s4, s4, 8347648
    v_mov_b32 v247, s4
    s_mov_b64 exec, 1
    s_mov_b32 s4, 0
POLL_3:
    buffer_load_dword v252, v247, s[92:95], 0 offen sc1
    s_add_u32 s4, s4, 1
    s_waitcnt vmcnt(0)
    v_cmp_gt_u32 vcc, 1, v252
    s_cmp_gt_u32 s4, 0x40000
    s_cbranch_scc1 POLL_3_x

    s_cbranch_vccnz POLL_3
POLL_3_x:
    s_mov_b64 exec, -1

ARR_2_d:
    v_mov_b32 v246, 153348
    v_mov_b32 v247, 1
    ds_write_b32 v246, v247

    s_branch M_S1OK
M_NOS1:
    v_mov_b32 v246, 153348
    s_mov_b32 s4, 0
LW_4:
    ds_read_b32 v247, v246
    s_add_u32 s4, s4, 1
    s_waitcnt lgkmcnt(0)
    v_cmp_gt_u32 vcc, 1, v247
    s_cmp_gt_u32 s4, 0x400000
    s_cbranch_scc1 LW_4_x
    s_cbranch_vccnz LW_4
LW_4_x:

M_S1OK:
    buffer_load_dwordx4 v1, s[20:23], 0 offen offset:0 sc1 lds
    buffer_load_dwordx4 v1, s[20:23], 0 offen offset:1024 sc1 lds
    buffer_load_dwordx4 v1, s[20:23], 0 offen offset:2048 sc1 lds
    buffer_load_dwordx4 v1, s[20:23], 0 offen offset:3072 sc1 lds
    s_add_u32 m0, s30, 16640
    s_nop 0
    buffer_load_dwordx4 v6, s[20:23], 0 offen offset:0 sc1 lds
    buffer_load_dwordx4 v6, s[20:23], 0 offen offset:1024 sc1 lds
    buffer_load_dwordx4 v6, s[20:23], 0 offen offset:2048 sc1 lds
    buffer_load_dwordx4 v6, s[20:23], 0 offen offset:3072 sc1 lds
    s_waitcnt vmcnt(0)
    v_mov_b32 v246, 153372
    v_mov_b32 v247, 1
    s_mov_b64 exec, 1
    ds_add_u32 v246, v247
    s_mov_b64 exec, -1

    ds_read_b128 v[80:83], v15 offset:3584
    ds_read_b128 v[84:87], v15 offset:3072
    ds_read_b128 v[88:91], v15 offset:2560
    ds_read_b128 v[92:95], v15 offset:2048
    ds_read_b128 v[96:99], v15 offset:1536
    ds_read_b128 v[100:103], v15 offset:1024
    ds_read_b128 v[104:107], v15 offset:512
    ds_read_b128 v[108:111], v15 offset:0
    s_mov_b32 s46, 0
M2_LOOP:
    s_waitcnt lgkmcnt(0)
    v_mfma_f32_16x16x32_bf16 v[16:19], v[48:51], v[80:83], v[16:19]
    ds_read_b128 v[112:115], v14 offset:64
    v_mfma_f32_16x16x32_bf16 v[20:23], v[48:51], v[84:87], v[20:23]
    v_mfma_f32_16x16x32_bf16 v[24:27], v[48:51], v[88:91], v[24:27]
    ds_read_b128 v[144:147], v15 offset:3648
    v_mfma_f32_16x16x32_bf16 v[28:31], v[48:51], v[92:95], v[28:31]
    v_mfma_f32_16x16x32_bf16 v[32:35], v[48:51], v[96:99], v[32:35]
    ds_read_b128 v[148:151], v15 offset:3136
    v_mfma_f32_16x16x32_bf16 v[36:39], v[48:51], v[100:103], v[36:39]
    v_mfma_f32_16x16x32_bf16 v[40:43], v[48:51], v[104:107], v[40:43]
    ds_read_b128 v[152:155], v15 offset:2624
    v_mfma_f32_16x16x32_bf16 v[44:47], v[48:51], v[108:111], v[44:47]
    v_mfma_f32_16x16x32_bf16 v[20:23], v[52:55], v[80:83], v[20:23]
    ds_read_b128 v[156:159], v15 offset:2112
    v_mfma_f32_16x16x32_bf16 v[24:27], v[52:55], v[84:87], v[24:27]
    v_mfma_f32_16x16x32_bf16 v[28:31], v[52:55], v[88:91], v[28:31]
    ds_read_b128 v[160:163], v15 offset:1600
    v_mfma_f32_16x16x32_bf16 v[32:35], v[52:55], v[92:95], v[32:35]
    v_mfma_f32_16x16x32_bf16 v[36:39], v[52:55], v[96:99], v[36:39]
    ds_read_b128 v[164:167], v15 offset:1088
    v_mfma_f32_16x16x32_bf16 v[40:43], v[52:55], v[100:103], v[40:43]
    v_mfma_f32_16x16x32_bf16 v[44:47], v[52:55], v[104:107], v[44:47]
    ds_read_b128 v[168:171], v15 offset:576
    v_mfma_f32_16x16x32_bf16 v[24:27], v[56:59], v[80:83], v[24:27]
    v_mfma_f32_16x16x32_bf16 v[28:31], v[56:59], v[84:87], v[28:31]
    ds_read_b128 v[172:175], v15 offset:64
    v_mfma_f32_16x16x32_bf16 v[32:35], v[56:59], v[88:91], v[32:35]
    v_mfma_f32_16x16x32_bf16 v[36:39], v[56:59], v[92:95], v[36:39]
    ds_read_b128 v[116:119], v14 offset:576
    v_mfma_f32_16x16x32_bf16 v[40:43], v[56:59], v[96:99], v[40:43]
    v_mfma_f32_16x16x32_bf16 v[44:47], v[56:59], v[100:103], v[44:47]
    ds_read_b128 v[120:123], v14 offset:1088
    v_mfma_f32_16x16x32_bf16 v[28:31], v[60:63], v[80:83], v[28:31]
    v_mfma_f32_16x16x32_bf16 v[32:35], v[60:63], v[84:87], v[32:35]
    ds_read_b128 v[124:127], v14 offset:1600
    v_mfma_f32_16x16x32_bf16 v[36:39], v[60:63], v[88:91], v[36:39]
    v_mfma_f32_16x16x32_bf16 v[40:43], v[60:63], v[92:95], v[40:43]
    ds_read_b128 v[128:131], v14 offset:2112
    v_mfma_f32_16x16x32_bf16 v[44:47], v[60:63], v[96:99], v[44:47]
    v_mfma_f32_16x16x32_bf16 v[32:35], v[64:67], v[80:83], v[32:35]
    ds_read_b128 v[132:135], v14 offset:2624
    v_mfma_f32_16x16x32_bf16 v[36:39], v[64:67], v[84:87], v[36:39]
    v_mfma_f32_16x16x32_bf16 v[40:43], v[64:67], v[88:91], v[40:43]
    ds_read_b128 v[136:139], v14 offset:3136
    v_mfma_f32_16x16x32_bf16 v[44:47], v[64:67], v[92:95], v[44:47]
    v_mfma_f32_16x16x32_bf16 v[36:39], v[68:71], v[80:83], v[36:39]
    ds_read_b128 v[140:143], v14 offset:3648
    v_mfma_f32_16x16x32_bf16 v[40:43], v[68:71], v[84:87], v[40:43]
    v_mfma_f32_16x16x32_bf16 v[44:47], v[68:71], v[88:91], v[44:47]
    v_mfma_f32_16x16x32_bf16 v[40:43], v[72:75], v[80:83], v[40:43]
    v_mfma_f32_16x16x32_bf16 v[44:47], v[72:75], v[84:87], v[44:47]
    v_mfma_f32_16x16x32_bf16 v[44:47], v[76:79], v[80:83], v[44:47]
    s_waitcnt lgkmcnt(0)
    v_mfma_f32_16x16x32_bf16 v[16:19], v[112:115], v[144:147], v[16:19]
    ds_read_b128 v[48:51], v14 offset:128
    v_mfma_f32_16x16x32_bf16 v[20:23], v[112:115], v[148:151], v[20:23]
    v_mfma_f32_16x16x32_bf16 v[24:27], v[112:115], v[152:155], v[24:27]
    ds_read_b128 v[80:83], v15 offset:3712
    v_mfma_f32_16x16x32_bf16 v[28:31], v[112:115], v[156:159], v[28:31]
    v_mfma_f32_16x16x32_bf16 v[32:35], v[112:115], v[160:163], v[32:35]
    ds_read_b128 v[84:87], v15 offset:3200
    v_mfma_f32_16x16x32_bf16 v[36:39], v[112:115], v[164:167], v[36:39]
    v_mfma_f32_16x16x32_bf16 v[40:43], v[112:115], v[168:171], v[40:43]
    ds_read_b128 v[88:91], v15 offset:2688
    v_mfma_f32_16x16x32_bf16 v[44:47], v[112:115], v[172:175], v[44:47]
    v_mfma_f32_16x16x32_bf16 v[20:23], v[116:119], v[144:147], v[20:23]
    ds_read_b128 v[92:95], v15 offset:2176
    v_mfma_f32_16x16x32_bf16 v[24:27], v[116:119], v[148:151], v[24:27]
    v_mfma_f32_16x16x32_bf16 v[28:31], v[116:119], v[152:155], v[28:31]
    ds_read_b128 v[96:99], v15 offset:1664
    v_mfma_f32_16x16x32_bf16 v[32:35], v[116:119], v[156:159], v[32:35]
    v_mfma_f32_16x16x32_bf16 v[36:39], v[116:119], v[160:163], v[36:39]
    ds_read_b128 v[100:103], v15 offset:1152
    v_mfma_f32_16x16x32_bf16 v[40:43], v[116:119], v[164:167], v[40:43]
    v_mfma_f32_16x16x32_bf16 v[44:47], v[116:119], v[168:171], v[44:47]
    ds_read_b128 v[104:107], v15 offset:640
    v_mfma_f32_16x16x32_bf16 v[24:27], v[120:123], v[144:147], v[24:27]
    v_mfma_f32_16x16x32_bf16 v[28:31], v[120:123], v[148:151], v[28:31]
    ds_read_b128 v[108:111], v15 offset:128
    v_mfma_f32_16x16x32_bf16 v[32:35], v[120:123], v[152:155], v[32:35]
    v_mfma_f32_16x16x32_bf16 v[36:39], v[120:123], v[156:159], v[36:39]
    ds_read_b128 v[52:55], v14 offset:640
    v_mfma_f32_16x16x32_bf16 v[40:43], v[120:123], v[160:163], v[40:43]
    v_mfma_f32_16x16x32_bf16 v[44:47], v[120:123], v[164:167], v[44:47]
    ds_read_b128 v[56:59], v14 offset:1152
    v_mfma_f32_16x16x32_bf16 v[28:31], v[124:127], v[144:147], v[28:31]
    v_mfma_f32_16x16x32_bf16 v[32:35], v[124:127], v[148:151], v[32:35]
    ds_read_b128 v[60:63], v14 offset:1664
    v_mfma_f32_16x16x32_bf16 v[36:39], v[124:127], v[152:155], v[36:39]
    v_mfma_f32_16x16x32_bf16 v[40:43], v[124:127], v[156:159], v[40:43]
    ds_read_b128 v[64:67], v14 offset:2176
    v_mfma_f32_16x16x32_bf16 v[44:47], v[124:127], v[160:163], v[44:47]
    v_mfma_f32_16x16x32_bf16 v[32:35], v[128:131], v[144:147], v[32:35]
    ds_read_b128 v[68:71], v14 offset:2688
    v_mfma_f32_16x16x32_bf16 v[36:39], v[128:131], v[148:151], v[36:39]
    v_mfma_f32_16x16x32_bf16 v[40:43], v[128:131], v[152:155], v[40:43]
    ds_read_b128 v[72:75], v14 offset:3200
    v_mfma_f32_16x16x32_bf16 v[44:47], v[128:131], v[156:159], v[44:47]
    v_mfma_f32_16x16x32_bf16 v[36:39], v[132:135], v[144:147], v[36:39]
    ds_read_b128 v[76:79], v14 offset:3712
    v_mfma_f32_16x16x32_bf16 v[40:43], v[132:135], v[148:151], v[40:43]
    v_mfma_f32_16x16x32_bf16 v[44:47], v[132:135], v[152:155], v[44:47]
    v_mfma_f32_16x16x32_bf16 v[40:43], v[136:139], v[144:147], v[40:43]
    v_add_u32 v14, 128, v14
    v_add_u32 v15, 128, v15
    s_add_u32 s46, s46, 1
    s_cmp_lt_u32 s46, 4
    v_mfma_f32_16x16x32_bf16 v[44:47], v[136:139], v[148:151], v[44:47]
    v_mfma_f32_16x16x32_bf16 v[44:47], v[140:143], v[144:147], v[44:47]
    s_cbranch_scc1 M2_LOOP
    s_waitcnt lgkmcnt(0)
    ds_read_b64 v[48:49], v11 offset:3584
    ds_read_b64 v[50:51], v11 offset:3072
    ds_read_b64 v[52:53], v11 offset:2560
    ds_read_b64 v[54:55], v11 offset:2048
    ds_read_b64 v[56:57], v11 offset:1536
    ds_read_b64 v[58:59], v11 offset:1024
    ds_read_b64 v[60:61], v11 offset:512
    ds_read_b64 v[62:63], v11 offset:0
    v_mov_b32 v246, 153376
    s_mov_b32 s4, 0
LW_5:
    ds_read_b32 v247, v246
    s_add_u32 s4, s4, 1
    s_waitcnt lgkmcnt(0)
    v_cmp_gt_u32 vcc, 1, v247
    s_cmp_gt_u32 s4, 0x400000
    s_cbranch_scc1 LW_5_x
    s_cbranch_vccnz LW_5
LW_5_x:

    ds_read_b64 v[160:161], v7 offset:0
    ds_read_b128 v[64:67], v13 offset:0
    ds_read_b128 v[96:99], v13 offset:8192
    ds_read_b64 v[162:163], v7 offset:512
    ds_read_b128 v[68:71], v13 offset:1024
    ds_read_b128 v[100:103], v13 offset:9216
    ds_read_b64 v[164:165], v7 offset:1024
    ds_read_b128 v[72:75], v13 offset:2048
    ds_read_b128 v[104:107], v13 offset:10240
    ds_read_b64 v[166:167], v7 offset:1536
    ds_read_b128 v[76:79], v13 offset:3072
    ds_read_b128 v[108:111], v13 offset:11264
    ds_read_b64 v[168:169], v7 offset:2048
    ds_read_b128 v[80:83], v13 offset:4096
    ds_read_b128 v[112:115], v13 offset:12288
    ds_read_b64 v[170:171], v7 offset:2560
    ds_read_b128 v[84:87], v13 offset:5120
    ds_read_b128 v[116:119], v13 offset:13312
    ds_read_b64 v[172:173], v7 offset:3072
    ds_read_b128 v[88:91], v13 offset:6144
    ds_read_b128 v[120:123], v13 offset:14336
    ds_read_b64 v[174:175], v7 offset:3584
    ds_read_b128 v[92:95], v13 offset:7168
    ds_read_b128 v[124:127], v13 offset:15360
    s_lshl_b32 s36, s28, 4
    s_and_b32 s36, s36, 16
    s_lshr_b32 s37, s37, s36
    s_lshl_b32 s37, s37, 16
    v_add_u32 v9, s30, v12
    s_waitcnt lgkmcnt(0)

    v_and_b32 v128, s40, v49
    v_lshlrev_b32 v129, 16, v49
    v_and_b32 v130, s40, v48
    v_lshlrev_b32 v131, 16, v48
    v_lshlrev_b32 v132, 16, v160
    v_and_b32 v133, s40, v160
    v_lshlrev_b32 v134, 16, v161
    v_and_b32 v135, s40, v161

    v_fmac_f32 v16, s37, v128
    v_fmac_f32 v17, s37, v129
    v_fmac_f32 v18, s37, v130
    v_fmac_f32 v19, s37, v131
    v_pk_fma_f32 v[136:137], v[132:133], v[64:65], v[96:97]
    v_pk_fma_f32 v[138:139], v[134:135], v[66:67], v[98:99]
    v_pk_fma_f32 v[128:129], v[16:17], v[136:137], v[132:133]
    v_pk_fma_f32 v[130:131], v[18:19], v[138:139], v[134:135]
    v_cvt_pk_bf16_f32 v140, v128, v129
    v_cvt_pk_bf16_f32 v141, v130, v131

    ds_write_b64 v9, v[140:141] offset:0
    v_and_b32 v144, s40, v51
    v_lshlrev_b32 v145, 16, v51
    v_and_b32 v146, s40, v50
    v_lshlrev_b32 v147, 16, v50
    v_lshlrev_b32 v148, 16, v162
    v_and_b32 v149, s40, v162
    v_lshlrev_b32 v150, 16, v163
    v_and_b32 v151, s40, v163

    v_fmac_f32 v20, s37, v144
    v_fmac_f32 v21, s37, v145
    v_fmac_f32 v22, s37, v146
    v_fmac_f32 v23, s37, v147
    v_pk_fma_f32 v[152:153], v[148:149], v[68:69], v[100:101]
    v_pk_fma_f32 v[154:155], v[150:151], v[70:71], v[102:103]
    v_pk_fma_f32 v[144:145], v[20:21], v[152:153], v[148:149]
    v_pk_fma_f32 v[146:147], v[22:23], v[154:155], v[150:151]
    v_cvt_pk_bf16_f32 v156, v144, v145
    v_cvt_pk_bf16_f32 v157, v146, v147

    ds_write_b64 v9, v[156:157] offset:512
    ds_read_b128 v[176:179], v193 offset:0
    v_and_b32 v128, s40, v53
    v_lshlrev_b32 v129, 16, v53
    v_and_b32 v130, s40, v52
    v_lshlrev_b32 v131, 16, v52
    v_lshlrev_b32 v132, 16, v164
    v_and_b32 v133, s40, v164
    v_lshlrev_b32 v134, 16, v165
    v_and_b32 v135, s40, v165

    v_fmac_f32 v24, s37, v128
    v_fmac_f32 v25, s37, v129
    v_fmac_f32 v26, s37, v130
    v_fmac_f32 v27, s37, v131
    v_pk_fma_f32 v[136:137], v[132:133], v[72:73], v[104:105]
    v_pk_fma_f32 v[138:139], v[134:135], v[74:75], v[106:107]
    v_pk_fma_f32 v[128:129], v[24:25], v[136:137], v[132:133]
    v_pk_fma_f32 v[130:131], v[26:27], v[138:139], v[134:135]
    v_cvt_pk_bf16_f32 v140, v128, v129
    v_cvt_pk_bf16_f32 v141, v130, v131

    ds_write_b64 v9, v[140:141] offset:1024
    v_and_b32 v144, s40, v55
    v_lshlrev_b32 v145, 16, v55
    v_and_b32 v146, s40, v54
    v_lshlrev_b32 v147, 16, v54
    v_lshlrev_b32 v148, 16, v166
    v_and_b32 v149, s40, v166
    v_lshlrev_b32 v150, 16, v167
    v_and_b32 v151, s40, v167

    v_fmac_f32 v28, s37, v144
    v_fmac_f32 v29, s37, v145
    v_fmac_f32 v30, s37, v146
    v_fmac_f32 v31, s37, v147
    v_pk_fma_f32 v[152:153], v[148:149], v[76:77], v[108:109]
    v_pk_fma_f32 v[154:155], v[150:151], v[78:79], v[110:111]
    v_pk_fma_f32 v[144:145], v[28:29], v[152:153], v[148:149]
    v_pk_fma_f32 v[146:147], v[30:31], v[154:155], v[150:151]
    v_cvt_pk_bf16_f32 v156, v144, v145
    v_cvt_pk_bf16_f32 v157, v146, v147

    ds_write_b64 v9, v[156:157] offset:1536
    ds_read_b128 v[180:183], v193 offset:1024
    s_waitcnt lgkmcnt(3)
    buffer_store_dwordx4 v[176:179], v1, s[92:95], s41 offen offset:0 sc1
    v_and_b32 v128, s40, v57
    v_lshlrev_b32 v129, 16, v57
    v_and_b32 v130, s40, v56
    v_lshlrev_b32 v131, 16, v56
    v_lshlrev_b32 v132, 16, v168
    v_and_b32 v133, s40, v168
    v_lshlrev_b32 v134, 16, v169
    v_and_b32 v135, s40, v169

    v_fmac_f32 v32, s37, v128
    v_fmac_f32 v33, s37, v129
    v_fmac_f32 v34, s37, v130
    v_fmac_f32 v35, s37, v131
    v_pk_fma_f32 v[136:137], v[132:133], v[80:81], v[112:113]
    v_pk_fma_f32 v[138:139], v[134:135], v[82:83], v[114:115]
    v_pk_fma_f32 v[128:129], v[32:33], v[136:137], v[132:133]
    v_pk_fma_f32 v[130:131], v[34:35], v[138:139], v[134:135]
    v_cvt_pk_bf16_f32 v140, v128, v129
    v_cvt_pk_bf16_f32 v141, v130, v131

    ds_write_b64 v9, v[140:141] offset:2048
    v_and_b32 v144, s40, v59
    v_lshlrev_b32 v145, 16, v59
    v_and_b32 v146, s40, v58
    v_lshlrev_b32 v147, 16, v58
    v_lshlrev_b32 v148, 16, v170
    v_and_b32 v149, s40, v170
    v_lshlrev_b32 v150, 16, v171
    v_and_b32 v151, s40, v171

    v_fmac_f32 v36, s37, v144
    v_fmac_f32 v37, s37, v145
    v_fmac_f32 v38, s37, v146
    v_fmac_f32 v39, s37, v147
    v_pk_fma_f32 v[152:153], v[148:149], v[84:85], v[116:117]
    v_pk_fma_f32 v[154:155], v[150:151], v[86:87], v[118:119]
    v_pk_fma_f32 v[144:145], v[36:37], v[152:153], v[148:149]
    v_pk_fma_f32 v[146:147], v[38:39], v[154:155], v[150:151]
    v_cvt_pk_bf16_f32 v156, v144, v145
    v_cvt_pk_bf16_f32 v157, v146, v147

    ds_write_b64 v9, v[156:157] offset:2560
    ds_read_b128 v[184:187], v193 offset:2048
    s_waitcnt lgkmcnt(3)
    buffer_store_dwordx4 v[180:183], v1, s[92:95], s41 offen offset:1024 sc1
    v_and_b32 v128, s40, v61
    v_lshlrev_b32 v129, 16, v61
    v_and_b32 v130, s40, v60
    v_lshlrev_b32 v131, 16, v60
    v_lshlrev_b32 v132, 16, v172
    v_and_b32 v133, s40, v172
    v_lshlrev_b32 v134, 16, v173
    v_and_b32 v135, s40, v173

    v_fmac_f32 v40, s37, v128
    v_fmac_f32 v41, s37, v129
    v_fmac_f32 v42, s37, v130
    v_fmac_f32 v43, s37, v131
    v_pk_fma_f32 v[136:137], v[132:133], v[88:89], v[120:121]
    v_pk_fma_f32 v[138:139], v[134:135], v[90:91], v[122:123]
    v_pk_fma_f32 v[128:129], v[40:41], v[136:137], v[132:133]
    v_pk_fma_f32 v[130:131], v[42:43], v[138:139], v[134:135]
    v_cvt_pk_bf16_f32 v140, v128, v129
    v_cvt_pk_bf16_f32 v141, v130, v131

    ds_write_b64 v9, v[140:141] offset:3072
    v_and_b32 v144, s40, v63
    v_lshlrev_b32 v145, 16, v63
    v_and_b32 v146, s40, v62
    v_lshlrev_b32 v147, 16, v62
    v_lshlrev_b32 v148, 16, v174
    v_and_b32 v149, s40, v174
    v_lshlrev_b32 v150, 16, v175
    v_and_b32 v151, s40, v175

    v_fmac_f32 v44, s37, v144
    v_fmac_f32 v45, s37, v145
    v_fmac_f32 v46, s37, v146
    v_fmac_f32 v47, s37, v147
    v_pk_fma_f32 v[152:153], v[148:149], v[92:93], v[124:125]
    v_pk_fma_f32 v[154:155], v[150:151], v[94:95], v[126:127]
    v_pk_fma_f32 v[144:145], v[44:45], v[152:153], v[148:149]
    v_pk_fma_f32 v[146:147], v[46:47], v[154:155], v[150:151]
    v_cvt_pk_bf16_f32 v156, v144, v145
    v_cvt_pk_bf16_f32 v157, v146, v147

    ds_write_b64 v9, v[156:157] offset:3584
    ds_read_b128 v[188:191], v193 offset:3072
    s_waitcnt lgkmcnt(3)
    buffer_store_dwordx4 v[184:187], v1, s[92:95], s41 offen offset:2048 sc1
    s_waitcnt lgkmcnt(0)
    buffer_store_dwordx4 v[188:191], v1, s[92:95], s41 offen offset:3072 sc1
    s_waitcnt vmcnt(0)
    v_mov_b32 v246, 153368
    v_mov_b32 v247, 1
    s_mov_b64 exec, 1
    ds_add_rtn_u32 v247, v246, v247
    s_waitcnt lgkmcnt(0)
    v_readfirstlane_b32 s4, v247
    s_mov_b64 exec, -1
    s_cmp_lg_u32 s4, 3
    s_cbranch_scc1 M_NOS2

    s_lshr_b32 s38, s90, 4
    s_lshl_b32 s39, s38, 10
    s_add_u32 s39, s39, 8331264
    s_lshl_b32 s38, s38, 7
    s_add_u32 s38, s38, 8257536

    v_mov_b32 v248, s38
    v_mov_b32 v249, 1
    s_mov_b64 exec, 1
    buffer_atomic_add v249, v248, s[92:95], 0 offen sc0 sc1
    s_waitcnt vmcnt(0)
    v_readfirstlane_b32 s4, v249
    s_mov_b64 exec, -1
    s_and_b32 s4, s4, 15
    s_cmp_lg_u32 s4, 15
    s_cbranch_scc1 ARR_6

    v_mov_b32 v251, 1
    v_lshlrev_b32 v250, 7, v0
    v_add_u32 v250, s39, v250

    s_mov_b64 exec, 0xff
    buffer_store_dword v251, v250, s[92:95], 0 offen sc1
    s_mov_b64 exec, -1
ARR_6:
M_NOS2:
    s_branch M_P2
M_LOWNC:
    s_cmp_lg_u32 s3, 3
    s_cbranch_scc1 M_PACK

    v_mov_b32 v246, 153344
    s_mov_b32 s4, 0
LW_7:
    ds_read_b32 v247, v246
    s_add_u32 s4, s4, 1
    s_waitcnt lgkmcnt(0)
    v_cmp_gt_u32 vcc, 7, v247
    s_cmp_gt_u32 s4, 0x400000
    s_cbranch_scc1 LW_7_x
    s_cbranch_vccnz LW_7
LW_7_x:

    s_lshr_b32 s38, s2, 5
    s_lshl_b32 s39, s38, 12
    s_add_u32 s39, s39, 8347648
    s_and_b32 s4, s38, 3
    s_lshl_b32 s4, s4, 6
    s_lshr_b32 s38, s38, 2
    s_lshl_b32 s38, s38, 4
    s_add_u32 s38, s38, s4

    v_mov_b32 v248, s38
    v_mov_b32 v249, 1
    s_mov_b64 exec, 1
    buffer_atomic_add v249, v248, s[96:99], 0 offen sc0 sc1
    s_waitcnt vmcnt(0)
    v_readfirstlane_b32 s4, v249
    s_mov_b64 exec, -1
    s_and_b32 s4, s4, 31
    s_cmp_lg_u32 s4, 31
    s_cbranch_scc1 ARR_8

    v_mov_b32 v251, 1
    v_lshlrev_b32 v250, 7, v0
    v_add_u32 v250, s39, v250

    s_mov_b64 exec, 0x7fffffff
    s_bitset1_b64 exec, 31
    buffer_store_dword v251, v250, s[92:95], 0 offen sc1
    s_mov_b64 exec, -1
    v_mov_b32 v246, 153396
    v_mov_b32 v247, 1
    ds_write_b32 v246, v247

    s_branch ARR_8_d
ARR_8:
    s_lshl_b32 s4, s2, 7
    s_add_u32 s4, s4, 8347648
    v_mov_b32 v247, s4
    s_mov_b64 exec, 1
    s_mov_b32 s4, 0
POLL_9:
    buffer_load_dword v252, v247, s[92:95], 0 offen sc1
    s_add_u32 s4, s4, 1
    s_waitcnt vmcnt(0)
    v_cmp_gt_u32 vcc, 1, v252
    s_cmp_gt_u32 s4, 0x40000
    s_cbranch_scc1 POLL_9_x

    s_cbranch_vccnz POLL_9
POLL_9_x:
    s_mov_b64 exec, -1

ARR_8_d:
    v_mov_b32 v246, 153348
    v_mov_b32 v247, 1
    ds_write_b32 v246, v247

    s_branch M_PACK
M_UPPER:
    s_mov_b32 s41, 0x05040100
    s_mov_b32 s42, 0x07060302
    v_lshl_add_u32 v5, v7, 3, v5
    s_lshl_b32 s31, s38, 1
    s_waitcnt lgkmcnt(0)
    s_mov_b32 s92, s88
    s_mov_b32 s93, s89
    s_mov_b32 s96, s86
    s_mov_b32 s97, s87

    s_mov_b32 s16, s64
    s_mov_b32 s17, s65
    s_mov_b32 s18, 2621440
    s_mov_b32 s19, 0x20000
    s_cmp_eq_u32 s3, 7
    s_cbranch_scc1 M_STATS
    s_getpc_b64 s[44:45]
M_PCREF:
    s_sub_u32 s44, s44, M_PCREF-sequential_preLN__ssm_conv_h3__glu_gated_reglu__prompt_kernel
    s_subb_u32 s45, s45, 0
    s_lshl_b32 s46, s5, 13
    v_lshlrev_b32 v8, 7, v0
    v_add_u32 v8, s46, v8
    v_min_u32 v8, M_CODE_END-sequential_preLN__ssm_conv_h3__glu_gated_reglu__prompt_kernel-4, v8
    s_nop 0

    s_barrier

    buffer_load_dwordx4 v[52:55], v1, s[16:19], 0 offen offset:0
    buffer_load_dwordx4 v[56:59], v1, s[16:19], 0 offen offset:1280
    buffer_load_dwordx4 v[60:63], v1, s[16:19], 0 offen offset:2560
    buffer_load_dwordx4 v[64:67], v1, s[16:19], 0 offen offset:3840
    s_cmp_lg_u32 s3, 6
    s_cbranch_scc1 M_NOTK
    s_mov_b32 s10, s2
    s_add_u32 s10, s10, 1
    v_mov_b32 v246, 153404
    v_mov_b32 v247, s10
    ds_write_b32 v246, v247

M_NOTK:
    s_mov_b32 s44, 0x05040100
    s_waitcnt vmcnt(0)
    v_perm_b32 v8, v56, v52, s44
    v_perm_b32 v9, v64, v60, s44
    ds_write_b64 v5, v[8:9] offset:0
    v_perm_b32 v10, v56, v52, s42
    v_perm_b32 v11, v64, v60, s42
    ds_write_b64 v5, v[10:11] offset:144
    v_perm_b32 v12, v57, v53, s44
    v_perm_b32 v13, v65, v61, s44
    ds_write_b64 v5, v[12:13] offset:288
    v_perm_b32 v14, v57, v53, s42
    v_perm_b32 v15, v65, v61, s42
    ds_write_b64 v5, v[14:15] offset:432
    v_perm_b32 v16, v58, v54, s44
    v_perm_b32 v17, v66, v62, s44
    ds_write_b64 v5, v[16:17] offset:576
    v_perm_b32 v18, v58, v54, s42
    v_perm_b32 v19, v66, v62, s42
    ds_write_b64 v5, v[18:19] offset:720
    v_perm_b32 v20, v59, v55, s44
    v_perm_b32 v21, v67, v63, s44
    ds_write_b64 v5, v[20:21] offset:864
    v_perm_b32 v22, v59, v55, s42
    v_perm_b32 v23, v67, v63, s42
    ds_write_b64 v5, v[22:23] offset:1008
    ds_read_b128 v[24:27], v189 offset:0
    ds_read_b128 v[28:31], v189 offset:288
    ds_read_b128 v[32:35], v189 offset:576
    ds_read_b128 v[36:39], v189 offset:864
    s_add_u32 s41, s31, 2621440
    s_waitcnt lgkmcnt(3)
    buffer_store_dwordx4 v[24:27], v4, s[92:95], s41 offen sc1

    s_add_u32 s41, s31, 2629632
    s_waitcnt lgkmcnt(2)
    buffer_store_dwordx4 v[28:31], v4, s[92:95], s41 offen sc1

    s_add_u32 s41, s31, 2637824
    s_waitcnt lgkmcnt(1)
    buffer_store_dwordx4 v[32:35], v4, s[92:95], s41 offen sc1

    s_add_u32 s41, s31, 2646016
    s_waitcnt lgkmcnt(0)
    buffer_store_dwordx4 v[36:39], v4, s[92:95], s41 offen sc1

    s_branch M_UPDONE
M_STATS:
    s_and_b32 s36, s2, 31
    s_lshl_b32 s36, s36, 6
    s_lshr_b32 s37, s2, 5
    s_lshl_b32 s37, s37, 3
    s_add_u32 s36, s36, s37
    v_and_b32 v6, 15, v0
    v_lshrrev_b32 v7, 4, v0
    v_add_u32 v7, s36, v7
    v_mul_u32_u24 v1, 1280, v7
    v_lshl_add_u32 v1, v6, 4, v1
    v_add_u32 v2, 5120, v1
    v_lshrrev_b32 v5, 4, v0
    v_lshlrev_b32 v5, 2, v5
    v_and_b32 v8, 1, v0
    v_lshl_add_u32 v5, v8, 5, v5
    v_add_u32 v5, 135168, v5
    v_lshlrev_b32 v12, 4, v8
    v_bfe_u32 v13, v0, 1, 1
    v_lshl_add_u32 v12, v13, 13, v12
    s_lshl_b32 s35, s36, 2
    s_add_u32 s35, s35, 7864320
    v_lshlrev_b32 v13, 4, v0
    v_add_u32 v13, 135168, v13
    v_lshlrev_b32 v9, 4, v0
    v_add_u32 v9, 8257536, v9
    v_mov_b32 v100, 0
    v_mov_b32 v101, 0
    v_mov_b32 v102, 0
    v_mov_b32 v103, 0
    s_and_b32 s36, s2, 31
    s_cmp_lg_u32 s36, 0
    s_cbranch_scc1 M_NOZERO0
    s_lshr_b32 s39, s2, 5
    s_mul_i32 s36, s39, 11264
    s_add_u32 s37, s36, 4096
    s_add_u32 s38, s36, 8192
    s_lshl_b32 s39, s39, 10
    s_add_u32 s39, s39, 122880

    buffer_store_dwordx4 v[100:103], v9, s[92:95], s36 offen offset:0 sc1
    buffer_store_dwordx4 v[100:103], v9, s[92:95], s36 offen offset:1024 sc1
    buffer_store_dwordx4 v[100:103], v9, s[92:95], s36 offen offset:2048 sc1
    buffer_store_dwordx4 v[100:103], v9, s[92:95], s36 offen offset:3072 sc1
    buffer_store_dwordx4 v[100:103], v9, s[92:95], s37 offen offset:0 sc1
    buffer_store_dwordx4 v[100:103], v9, s[92:95], s37 offen offset:1024 sc1
    buffer_store_dwordx4 v[100:103], v9, s[92:95], s37 offen offset:2048 sc1
    buffer_store_dwordx4 v[100:103], v9, s[92:95], s37 offen offset:3072 sc1
    buffer_store_dwordx4 v[100:103], v9, s[92:95], s38 offen offset:0 sc1
    buffer_store_dwordx4 v[100:103], v9, s[92:95], s38 offen offset:1024 sc1
    buffer_store_dwordx4 v[100:103], v9, s[92:95], s38 offen offset:2048 sc1
    buffer_store_dwordx4 v[100:103], v9, s[92:95], s39 offen sc1
M_NOZERO0:
    s_barrier
M_NOZERO:

    buffer_load_dwordx4 v[16:19], v1, s[16:19], 0 offen offset:0
    buffer_load_dwordx4 v[20:23], v1, s[16:19], 0 offen offset:256
    buffer_load_dwordx4 v[24:27], v1, s[16:19], 0 offen offset:512
    buffer_load_dwordx4 v[28:31], v1, s[16:19], 0 offen offset:768
    buffer_load_dwordx4 v[32:35], v1, s[16:19], 0 offen offset:1024
    buffer_load_dwordx4 v[36:39], v2, s[16:19], 0 offen offset:0
    buffer_load_dwordx4 v[40:43], v2, s[16:19], 0 offen offset:256
    buffer_load_dwordx4 v[44:47], v2, s[16:19], 0 offen offset:512
    buffer_load_dwordx4 v[48:51], v2, s[16:19], 0 offen offset:768
    buffer_load_dwordx4 v[52:55], v2, s[16:19], 0 offen offset:1024
    s_waitcnt vmcnt(0)
    v_cmp_eq_u32 vcc, 0, v8
    v_dot2_f32_bf16 v100, v16, s43, v100
    v_dot2_f32_bf16 v101, v16, v16, v101
    v_dot2_f32_bf16 v100, v17, s43, v100
    v_dot2_f32_bf16 v101, v17, v17, v101
    v_dot2_f32_bf16 v100, v18, s43, v100
    v_dot2_f32_bf16 v101, v18, v18, v101
    v_dot2_f32_bf16 v100, v19, s43, v100
    v_dot2_f32_bf16 v101, v19, v19, v101
    v_dot2_f32_bf16 v100, v20, s43, v100
    v_dot2_f32_bf16 v101, v20, v20, v101
    v_dot2_f32_bf16 v100, v21, s43, v100
    v_dot2_f32_bf16 v101, v21, v21, v101
    v_dot2_f32_bf16 v100, v22, s43, v100
    v_dot2_f32_bf16 v101, v22, v22, v101
    v_dot2_f32_bf16 v100, v23, s43, v100
    v_dot2_f32_bf16 v101, v23, v23, v101
    v_dot2_f32_bf16 v100, v24, s43, v100
    v_dot2_f32_bf16 v101, v24, v24, v101
    v_dot2_f32_bf16 v100, v25, s43, v100
    v_dot2_f32_bf16 v101, v25, v25, v101
    v_dot2_f32_bf16 v100, v26, s43, v100
    v_dot2_f32_bf16 v101, v26, v26, v101
    v_dot2_f32_bf16 v100, v27, s43, v100
    v_dot2_f32_bf16 v101, v27, v27, v101
    v_dot2_f32_bf16 v100, v28, s43, v100
    v_dot2_f32_bf16 v101, v28, v28, v101
    v_dot2_f32_bf16 v100, v29, s43, v100
    v_dot2_f32_bf16 v101, v29, v29, v101
    v_dot2_f32_bf16 v100, v30, s43, v100
    v_dot2_f32_bf16 v101, v30, v30, v101
    v_dot2_f32_bf16 v100, v31, s43, v100
    v_dot2_f32_bf16 v101, v31, v31, v101
    v_dot2_f32_bf16 v100, v32, s43, v100
    v_dot2_f32_bf16 v101, v32, v32, v101
    v_dot2_f32_bf16 v100, v33, s43, v100
    v_dot2_f32_bf16 v101, v33, v33, v101
    v_dot2_f32_bf16 v100, v34, s43, v100
    v_dot2_f32_bf16 v101, v34, v34, v101
    v_dot2_f32_bf16 v100, v35, s43, v100
    v_dot2_f32_bf16 v101, v35, v35, v101
    v_dot2_f32_bf16 v102, v36, s43, v102
    v_dot2_f32_bf16 v103, v36, v36, v103
    v_dot2_f32_bf16 v102, v37, s43, v102
    v_dot2_f32_bf16 v103, v37, v37, v103
    v_dot2_f32_bf16 v102, v38, s43, v102
    v_dot2_f32_bf16 v103, v38, v38, v103
    v_dot2_f32_bf16 v102, v39, s43, v102
    v_dot2_f32_bf16 v103, v39, v39, v103
    v_dot2_f32_bf16 v102, v40, s43, v102
    v_dot2_f32_bf16 v103, v40, v40, v103
    v_dot2_f32_bf16 v102, v41, s43, v102
    v_dot2_f32_bf16 v103, v41, v41, v103
    v_dot2_f32_bf16 v102, v42, s43, v102
    v_dot2_f32_bf16 v103, v42, v42, v103
    v_dot2_f32_bf16 v102, v43, s43, v102
    v_dot2_f32_bf16 v103, v43, v43, v103
    v_dot2_f32_bf16 v102, v44, s43, v102
    v_dot2_f32_bf16 v103, v44, v44, v103
    v_dot2_f32_bf16 v102, v45, s43, v102
    v_dot2_f32_bf16 v103, v45, v45, v103
    v_dot2_f32_bf16 v102, v46, s43, v102
    v_dot2_f32_bf16 v103, v46, v46, v103
    v_dot2_f32_bf16 v102, v47, s43, v102
    v_dot2_f32_bf16 v103, v47, v47, v103
    v_dot2_f32_bf16 v102, v48, s43, v102
    v_dot2_f32_bf16 v103, v48, v48, v103
    v_dot2_f32_bf16 v102, v49, s43, v102
    v_dot2_f32_bf16 v103, v49, v49, v103
    v_dot2_f32_bf16 v102, v50, s43, v102
    v_dot2_f32_bf16 v103, v50, v50, v103
    v_dot2_f32_bf16 v102, v51, s43, v102
    v_dot2_f32_bf16 v103, v51, v51, v103
    v_dot2_f32_bf16 v102, v52, s43, v102
    v_dot2_f32_bf16 v103, v52, v52, v103
    v_dot2_f32_bf16 v102, v53, s43, v102
    v_dot2_f32_bf16 v103, v53, v53, v103
    v_dot2_f32_bf16 v102, v54, s43, v102
    v_dot2_f32_bf16 v103, v54, v54, v103
    v_dot2_f32_bf16 v102, v55, s43, v102
    v_dot2_f32_bf16 v103, v55, v55, v103
    s_nop 2
    v_add_f32_dpp v100, v100, v100 row_ror:8 row_mask:0xf bank_mask:0xf
    v_add_f32_dpp v101, v101, v101 row_ror:8 row_mask:0xf bank_mask:0xf
    v_add_f32_dpp v102, v102, v102 row_ror:8 row_mask:0xf bank_mask:0xf
    v_add_f32_dpp v103, v103, v103 row_ror:8 row_mask:0xf bank_mask:0xf
    v_add_f32_dpp v100, v100, v100 row_ror:4 row_mask:0xf bank_mask:0xf
    v_add_f32_dpp v101, v101, v101 row_ror:4 row_mask:0xf bank_mask:0xf
    v_add_f32_dpp v102, v102, v102 row_ror:4 row_mask:0xf bank_mask:0xf
    v_add_f32_dpp v103, v103, v103 row_ror:4 row_mask:0xf bank_mask:0xf
    v_add_f32_dpp v100, v100, v100 row_ror:2 row_mask:0xf bank_mask:0xf
    v_add_f32_dpp v101, v101, v101 row_ror:2 row_mask:0xf bank_mask:0xf
    v_add_f32_dpp v102, v102, v102 row_ror:2 row_mask:0xf bank_mask:0xf
    v_add_f32_dpp v103, v103, v103 row_ror:2 row_mask:0xf bank_mask:0xf
    v_add_f32_dpp v100, v100, v100 row_ror:1 row_mask:0xf bank_mask:0xf
    v_add_f32_dpp v101, v101, v101 row_ror:1 row_mask:0xf bank_mask:0xf
    v_add_f32_dpp v102, v102, v102 row_ror:1 row_mask:0xf bank_mask:0xf
    v_add_f32_dpp v103, v103, v103 row_ror:1 row_mask:0xf bank_mask:0xf
    s_mov_b32 s44, 0x3acccccd
    s_mov_b32 s45, 0x3727c5ac
    v_mul_f32 v100, s44, v100
    v_mul_f32 v101, s44, v101
    v_fma_f32 v101, -v100, v100, v101
    v_max_f32 v101, 0, v101
    v_add_f32 v101, s45, v101
    v_rsq_f32 v101, v101
    s_nop 0
    v_mul_f32 v100, v100, v101
    v_sub_f32 v100, 0, v100
    v_cndmask_b32 v100, v100, v101, vcc
    ds_write_b32 v5, v100 offset:0

    v_mul_f32 v102, s44, v102
    v_mul_f32 v103, s44, v103
    v_fma_f32 v103, -v102, v102, v103
    v_max_f32 v103, 0, v103
    v_add_f32 v103, s45, v103
    v_rsq_f32 v103, v103
    s_nop 0
    v_mul_f32 v102, v102, v103
    v_sub_f32 v102, 0, v102
    v_cndmask_b32 v102, v102, v103, vcc
    ds_write_b32 v5, v102 offset:16

    s_mov_b64 exec, 15
    ds_read_b128 v[16:19], v13
    s_waitcnt lgkmcnt(0)
    buffer_store_dwordx4 v[16:19], v12, s[92:95], s35 offen sc1
    s_mov_b64 exec, -1

M_UPDONE:
    s_waitcnt vmcnt(0)

    v_mov_b32 v246, 153344
    v_mov_b32 v247, 1
    s_mov_b64 exec, 1
    ds_add_u32 v246, v247
    s_mov_b64 exec, -1

    s_cmp_lg_u32 s3, 4
    s_cbranch_scc1 M_UPNA
    v_lshlrev_b32 v1, 4, v0
    s_mov_b32 s36, 7864320
    s_lshl_b32 s37, s90, 14
    s_add_u32 s37, s37, 2621440

    v_mov_b32 v246, 153348
    s_mov_b32 s4, 0
LW_10:
    ds_read_b32 v247, v246
    s_add_u32 s4, s4, 1
    s_waitcnt lgkmcnt(0)
    v_cmp_gt_u32 vcc, 1, v247
    s_cmp_gt_u32 s4, 0x400000
    s_cbranch_scc1 LW_10_x
    s_cbranch_vccnz LW_10
LW_10_x:

    v_mov_b32 v246, 153396
    ds_read_b32 v247, v246
    s_waitcnt lgkmcnt(0)
    v_cmp_eq_u32 vcc, 0, v247
    s_cbranch_vccnz M_NOTOP

    v_mov_b32 v248, 32
    v_mov_b32 v249, 1
    s_mov_b64 exec, 1
    buffer_atomic_add v249, v248, s[96:99], 0 offen sc0 sc1
    s_waitcnt vmcnt(0)
    v_readfirstlane_b32 s4, v249
    s_mov_b64 exec, -1
    s_and_b32 s4, s4, 7
    s_cmp_lg_u32 s4, 7
    s_cbranch_scc1 M_NOTOP

    v_mov_b32 v251, 1
    v_lshlrev_b32 v250, 10, v0
    v_add_u32 v250, 8380672, v250
    s_mov_b64 exec, 0xff
    buffer_store_dword v251, v250, s[92:95], 0 offen sc1
    s_mov_b64 exec, -1

M_NOTOP:
    s_cmp_ge_u32 s90, 160
    s_cbranch_scc1 M_NOXD
    v_mov_b32 v246, 153372
    s_mov_b32 s4, 0
LW_11:
    ds_read_b32 v247, v246
    s_add_u32 s4, s4, 1
    s_waitcnt lgkmcnt(0)
    v_cmp_gt_u32 vcc, 4, v247
    s_cmp_gt_u32 s4, 0x400000
    s_cbranch_scc1 LW_11_x
    s_cbranch_vccnz LW_11
LW_11_x:

    s_mov_b32 m0, 120832
    s_nop 0
    buffer_load_dwordx4 v1, s[92:95], s37 offen offset:0 sc1 lds
    buffer_load_dwordx4 v1, s[92:95], s37 offen offset:1024 sc1 lds
    buffer_load_dwordx4 v1, s[92:95], s37 offen offset:2048 sc1 lds
    buffer_load_dwordx4 v1, s[92:95], s37 offen offset:3072 sc1 lds
    s_add_u32 s37, s37, 4096
    s_mov_b32 m0, 124928
    s_nop 0
    buffer_load_dwordx4 v1, s[92:95], s37 offen offset:0 sc1 lds
    buffer_load_dwordx4 v1, s[92:95], s37 offen offset:1024 sc1 lds
    buffer_load_dwordx4 v1, s[92:95], s37 offen offset:2048 sc1 lds
    buffer_load_dwordx4 v1, s[92:95], s37 offen offset:3072 sc1 lds
    s_add_u32 s37, s37, 4096
    s_mov_b32 m0, 129024
    s_nop 0
    buffer_load_dwordx4 v1, s[92:95], s37 offen offset:0 sc1 lds
    buffer_load_dwordx4 v1, s[92:95], s37 offen offset:1024 sc1 lds
    buffer_load_dwordx4 v1, s[92:95], s37 offen offset:2048 sc1 lds
    buffer_load_dwordx4 v1, s[92:95], s37 offen offset:3072 sc1 lds
    s_add_u32 s37, s37, 4096
    s_mov_b32 m0, 133120
    s_nop 0
    buffer_load_dwordx4 v1, s[92:95], s37 offen offset:0 sc1 lds
    buffer_load_dwordx4 v1, s[92:95], s37 offen offset:1024 sc1 lds
    buffer_load_dwordx4 v1, s[92:95], s37 offen offset:2048 sc1 lds
    buffer_load_dwordx4 v1, s[92:95], s37 offen offset:3072 sc1 lds
    s_add_u32 s37, s37, 4096
M_NOXD:
    s_lshr_b32 s4, s2, 5
    s_lshl_b32 s4, s4, 10
    s_add_u32 s4, s4, 8380672
    v_mov_b32 v247, s4
    s_mov_b64 exec, 1
    s_mov_b32 s4, 0
POLL_12:
    buffer_load_dword v252, v247, s[92:95], 0 offen sc1
    s_add_u32 s4, s4, 1
    s_waitcnt vmcnt(0)
    v_cmp_gt_u32 vcc, 1, v252
    s_cmp_gt_u32 s4, 0x40000
    s_cbranch_scc1 POLL_12_x

    s_cbranch_vccnz POLL_12
POLL_12_x:
    s_mov_b64 exec, -1

    v_mov_b32 v246, 153356
    v_mov_b32 v247, 1
    ds_write_b32 v246, v247

    v_mov_b32 v246, 153360
    v_mov_b32 v247, 1
    ds_write_b32 v246, v247

    s_cmp_ge_u32 s90, 160
    s_cbranch_scc1 M_PACK
    s_mov_b32 m0, 104448
    s_nop 0
    buffer_load_dwordx4 v1, s[92:95], s36 offen offset:0 sc1 lds
    buffer_load_dwordx4 v1, s[92:95], s36 offen offset:1024 sc1 lds
    buffer_load_dwordx4 v1, s[92:95], s36 offen offset:2048 sc1 lds
    buffer_load_dwordx4 v1, s[92:95], s36 offen offset:3072 sc1 lds
    s_add_u32 s36, s36, 4096
    s_mov_b32 m0, 108544
    s_nop 0
    buffer_load_dwordx4 v1, s[92:95], s36 offen offset:0 sc1 lds
    buffer_load_dwordx4 v1, s[92:95], s36 offen offset:1024 sc1 lds
    buffer_load_dwordx4 v1, s[92:95], s36 offen offset:2048 sc1 lds
    buffer_load_dwordx4 v1, s[92:95], s36 offen offset:3072 sc1 lds
    s_add_u32 s36, s36, 4096
    s_mov_b32 m0, 112640
    s_nop 0
    buffer_load_dwordx4 v1, s[92:95], s36 offen offset:0 sc1 lds
    buffer_load_dwordx4 v1, s[92:95], s36 offen offset:1024 sc1 lds
    buffer_load_dwordx4 v1, s[92:95], s36 offen offset:2048 sc1 lds
    buffer_load_dwordx4 v1, s[92:95], s36 offen offset:3072 sc1 lds
    s_add_u32 s36, s36, 4096
    s_mov_b32 m0, 116736
    s_nop 0
    buffer_load_dwordx4 v1, s[92:95], s36 offen offset:0 sc1 lds
    buffer_load_dwordx4 v1, s[92:95], s36 offen offset:1024 sc1 lds
    buffer_load_dwordx4 v1, s[92:95], s36 offen offset:2048 sc1 lds
    buffer_load_dwordx4 v1, s[92:95], s36 offen offset:3072 sc1 lds
    s_add_u32 s36, s36, 4096
    s_waitcnt vmcnt(0)
    v_mov_b32 v246, 153376
    v_mov_b32 v247, 1
    ds_write_b32 v246, v247

    s_branch M_UPC
M_UPNA:
    s_cmp_ge_u32 s90, 160
    s_cbranch_scc1 M_PACK
M_UPC:

    v_mov_b32 v246, 153376
    s_mov_b32 s4, 0
LW_13:
    ds_read_b32 v247, v246
    s_add_u32 s4, s4, 1
    s_waitcnt lgkmcnt(0)
    v_cmp_gt_u32 vcc, 1, v247
    s_cmp_gt_u32 s4, 0x400000
    s_cbranch_scc1 LW_13_x
    s_cbranch_vccnz LW_13
LW_13_x:

M_W4PRE:

    v_mov_b32 v246, 153404
    s_mov_b32 s4, 0
LW_14:
    ds_read_b32 v247, v246
    s_add_u32 s4, s4, 1
    s_waitcnt lgkmcnt(0)
    v_cmp_gt_u32 vcc, 1, v247
    s_cmp_gt_u32 s4, 0x400000
    s_cbranch_scc1 LW_14_x
    s_cbranch_vccnz LW_14
LW_14_x:

    v_readfirstlane_b32 s91, v247
    s_nop 0
    s_sub_u32 s91, s91, 1
    s_and_b32 s8, s91, 7
    s_lshr_b32 s7, s8, 2
    s_lshl_b32 s7, s7, 3
    s_lshr_b32 s8, s91, 5
    s_add_u32 s7, s7, s8
    s_lshr_b32 s12, s7, 1
    s_mul_i32 s8, s12, 245760
    s_add_u32 s8, s8, 12582912
    s_mul_i32 s12, s3, 30720
    s_add_u32 s31, s8, s12
    v_lshlrev_b32 v4, 4, v0

    s_cmp_ge_u32 s90, 160
    s_cbranch_scc1 M_W4W
    v_mov_b32 v246, 153392
    v_mov_b32 v247, 1
    s_mov_b64 exec, 1
    ds_add_rtn_u32 v247, v246, v247
    s_waitcnt lgkmcnt(0)
    v_readfirstlane_b32 s4, v247
    s_mov_b64 exec, -1
    s_cmp_lg_u32 s4, 0
    s_cbranch_scc1 M_W4W

    v_mov_b32 v246, 153348
    s_mov_b32 s4, 0
LW_15:
    ds_read_b32 v247, v246
    s_add_u32 s4, s4, 1
    s_waitcnt lgkmcnt(0)
    v_cmp_gt_u32 vcc, 1, v247
    s_cmp_gt_u32 s4, 0x400000
    s_cbranch_scc1 LW_15_x
    s_cbranch_vccnz LW_15
LW_15_x:

    s_lshr_b32 s4, s2, 5
    s_lshl_b32 s4, s4, 10
    s_add_u32 s4, s4, 8380800
    v_mov_b32 v247, s4
    s_mov_b64 exec, 1
    s_mov_b32 s4, 0
POLL_16:
    buffer_load_dword v252, v247, s[92:95], 0 offen sc1
    s_add_u32 s4, s4, 1
    s_waitcnt vmcnt(0)
    v_cmp_gt_u32 vcc, 1, v252
    s_cmp_gt_u32 s4, 0x40000
    s_cbranch_scc1 POLL_16_x

    s_cbranch_vccnz POLL_16
POLL_16_x:
    s_mov_b64 exec, -1

    v_mov_b32 v246, 153388
    v_mov_b32 v247, 1
    ds_write_b32 v246, v247

M_W4W:
    v_mov_b32 v246, 153388
    s_mov_b32 s4, 0
LW_17:
    ds_read_b32 v247, v246
    s_add_u32 s4, s4, 1
    s_waitcnt lgkmcnt(0)
    v_cmp_gt_u32 vcc, 1, v247
    s_cmp_gt_u32 s4, 0x400000
    s_cbranch_scc1 LW_17_x
    s_cbranch_vccnz LW_17
LW_17_x:

    buffer_load_dwordx4 v[86:89], v4, s[92:95], s31 offen offset:0 sc1
    buffer_load_dwordx4 v[90:93], v4, s[92:95], s31 offen offset:1024 sc1
    buffer_load_dwordx4 v[94:97], v4, s[92:95], s31 offen offset:2048 sc1
    buffer_load_dwordx4 v[98:101], v4, s[92:95], s31 offen offset:3072 sc1
    s_add_u32 s31, s31, 4096
    buffer_load_dwordx4 v[102:105], v4, s[92:95], s31 offen offset:0 sc1
    buffer_load_dwordx4 v[106:109], v4, s[92:95], s31 offen offset:1024 sc1
    buffer_load_dwordx4 v[110:113], v4, s[92:95], s31 offen offset:2048 sc1
    buffer_load_dwordx4 v[114:117], v4, s[92:95], s31 offen offset:3072 sc1
    s_add_u32 s31, s31, 4096
    buffer_load_dwordx4 v[118:121], v4, s[92:95], s31 offen offset:0 sc1
    buffer_load_dwordx4 v[122:125], v4, s[92:95], s31 offen offset:1024 sc1
    buffer_load_dwordx4 v[126:129], v4, s[92:95], s31 offen offset:2048 sc1
    buffer_load_dwordx4 v[130:133], v4, s[92:95], s31 offen offset:3072 sc1
    s_add_u32 s31, s31, 4096
    buffer_load_dwordx4 v[134:137], v4, s[92:95], s31 offen offset:0 sc1
    buffer_load_dwordx4 v[138:141], v4, s[92:95], s31 offen offset:1024 sc1
    buffer_load_dwordx4 v[142:145], v4, s[92:95], s31 offen offset:2048 sc1
    buffer_load_dwordx4 v[146:149], v4, s[92:95], s31 offen offset:3072 sc1
    s_add_u32 s31, s31, 4096
    buffer_load_dwordx4 v[150:153], v4, s[92:95], s31 offen offset:0 sc1
    buffer_load_dwordx4 v[154:157], v4, s[92:95], s31 offen offset:1024 sc1
    buffer_load_dwordx4 v[158:161], v4, s[92:95], s31 offen offset:2048 sc1
    buffer_load_dwordx4 v[162:165], v4, s[92:95], s31 offen offset:3072 sc1
    s_add_u32 s31, s31, 4096
    buffer_load_dwordx4 v[166:169], v4, s[92:95], s31 offen offset:0 sc1
    buffer_load_dwordx4 v[170:173], v4, s[92:95], s31 offen offset:1024 sc1
    buffer_load_dwordx4 v[174:177], v4, s[92:95], s31 offen offset:2048 sc1
    buffer_load_dwordx4 v[178:181], v4, s[92:95], s31 offen offset:3072 sc1
    s_add_u32 s31, s31, 4096
    buffer_load_dwordx4 v[182:185], v4, s[92:95], s31 offen offset:0 sc1
    buffer_load_dwordx4 v[186:189], v4, s[92:95], s31 offen offset:1024 sc1
    buffer_load_dwordx4 v[190:193], v4, s[92:95], s31 offen offset:2048 sc1
    buffer_load_dwordx4 v[194:197], v4, s[92:95], s31 offen offset:3072 sc1
    s_add_u32 s31, s31, 4096
    buffer_load_dwordx4 v[198:201], v4, s[92:95], s31 offen offset:0 sc1
    buffer_load_dwordx4 v[202:205], v4, s[92:95], s31 offen offset:1024 sc1
    s_cmp_lt_u32 s90, 160
    s_cbranch_scc1 M_P2
    s_waitcnt vmcnt(30)
    s_branch M_PKRET

M_PACK:
    s_sub_u32 s28, s90, 160
    s_mul_i32 s33, s28, 3
    s_add_u32 s33, s33, s3
    s_add_u32 s33, s33, 480
    s_min_u32 s33, s33, 720
    s_mul_i32 s34, s28, 5
    s_add_u32 s34, s34, s3
    s_sub_u32 s34, s34, 3
    s_cmp_lt_u32 s3, 3
    s_cselect_b32 s28, s33, s34
    v_lshlrev_b32 v1, 4, v0
    v_lshrrev_b32 v3, 4, v0
    s_lshl_b32 s30, s3, 13
    s_mov_b32 s19, 0x20000
    s_mov_b32 s23, 0x20000
    v_and_b32 v28, 1, v3
    v_lshlrev_b32 v28, 12, v28
    v_lshrrev_b32 v29, 1, v3
    v_bfe_u32 v30, v0, 2, 2
    v_lshl_add_u32 v29, v29, 3, v30
    v_lshl_add_u32 v28, v29, 7, v28
    v_and_b32 v29, 3, v0
    v_lshl_add_u32 v28, v29, 3, v28
    v_add_u32 v28, s30, v28
    v_lshlrev_b32 v29, 2, v0
    v_cmp_gt_u32 vcc, 32, v0
    v_mov_b32 v30, 0x40000000
    v_lshrrev_b32 v31, 3, v0
    v_cndmask_b32 v29, v30, v29, vcc
    v_lshrrev_b32 v26, 5, v0
    v_and_b32 v27, 7, v0
    s_sub_u32 s45, s28, 480
    s_cmp_ge_u32 s28, 480

    s_cselect_b32 s44, s45, s28
    s_cselect_b32 s45, 10, 24
    s_mov_b32 s46, 2731
    s_cmov_b32 s46, 6554
    s_mov_b32 s47, 98304
    s_cmov_b32 s47, 81920
    s_mov_b32 s48, 3072
    s_cmov_b32 s48, 1280
    s_cselect_b32 s49, 4, 0
    s_mov_b32 s50, 24576
    s_cmov_b32 s50, 20480
    s_cselect_b32 s51, 5, 6
    s_mov_b32 s56, 6144
    s_cmov_b32 s56, 5120
    s_cselect_b32 s60, 48, 40
    s_mov_b32 s61, 1073741824
    s_cmov_b32 s61, 12582912
    s_mov_b32 s62, 10923
    s_cmov_b32 s62, 13108
    s_cselect_b32 s16, s82, s78
    s_cselect_b32 s17, s83, s79
    s_cselect_b32 s20, s82, s80
    s_cselect_b32 s21, s83, s81
    s_cselect_b32 s31, 5120, 0
    s_mov_b32 s32, 8269824
    s_cmov_b32 s32, 1073741824
    s_cmp_lt_u32 s28, 720
    s_cselect_b32 s18, 1966080, 0
    s_cselect_b32 s33, 0, 0x40000000
    s_mov_b32 s22, s18
    s_add_u32 s61, s61, s33
    s_mul_i32 s46, s44, s46
    s_lshr_b32 s46, s46, 16
    s_mul_i32 s45, s46, s45
    s_sub_u32 s45, s44, s45
    s_mul_i32 s47, s46, s47
    s_lshl_b32 s33, s45, 7
    s_add_u32 s47, s47, s33
    v_mad_u32_u24 v25, v26, s49, v31
    v_mul_u32_u24 v25, s48, v25
    v_lshl_add_u32 v25, v27, 4, v25
    s_add_u32 s31, s31, s47

    s_cmp_lt_u32 s3, 3
    s_cbranch_scc1 M_NOGATE
    v_mov_b32 v246, 153348
    s_mov_b32 s4, 0
LW_18:
    ds_read_b32 v247, v246
    s_add_u32 s4, s4, 1
    s_waitcnt lgkmcnt(0)
    v_cmp_gt_u32 vcc, 1, v247
    s_cmp_gt_u32 s4, 0x400000
    s_cbranch_scc1 LW_18_x
    s_cbranch_vccnz LW_18
LW_18_x:

M_NOGATE:
    s_add_u32 m0, s30, 0
    s_nop 0
    buffer_load_dwordx4 v25, s[16:19], s47 offen lds
    s_add_u32 s47, s47, s50
    s_add_u32 m0, s30, 1024
    s_nop 0
    buffer_load_dwordx4 v25, s[16:19], s47 offen lds
    s_add_u32 s47, s47, s50
    s_add_u32 m0, s30, 2048
    s_nop 0
    buffer_load_dwordx4 v25, s[16:19], s47 offen lds
    s_add_u32 s47, s47, s50
    s_add_u32 m0, s30, 3072
    s_nop 0
    buffer_load_dwordx4 v25, s[16:19], s47 offen lds
    s_add_u32 s47, s47, s50
    s_add_u32 m0, s30, 4096
    s_nop 0
    buffer_load_dwordx4 v25, s[20:23], s31 offen lds
    s_add_u32 s31, s31, s50
    s_add_u32 m0, s30, 5120
    s_nop 0
    buffer_load_dwordx4 v25, s[20:23], s31 offen lds
    s_add_u32 s31, s31, s50
    s_add_u32 m0, s30, 6144
    s_nop 0
    buffer_load_dwordx4 v25, s[20:23], s31 offen lds
    s_add_u32 s31, s31, s50
    s_add_u32 m0, s30, 7168
    s_nop 0
    buffer_load_dwordx4 v25, s[20:23], s31 offen lds
    s_add_u32 s31, s31, s50
    s_lshl_b32 s33, s45, 2
    s_add_u32 s33, s33, 0
    s_mul_i32 s34, s33, s62
    s_lshr_b32 s34, s34, 16
    s_mul_i32 s35, s34, s51
    s_sub_u32 s35, s33, s35
    s_mul_i32 s34, s34, s60
    s_lshl_b32 s33, s46, 1
    s_add_u32 s34, s34, s33
    s_mul_i32 s34, s34, s51
    s_add_u32 s34, s34, s35
    s_lshl_b32 s34, s34, 10
    s_add_u32 s52, s34, s61

    s_lshl_b32 s33, s45, 2
    s_add_u32 s33, s33, 1
    s_mul_i32 s34, s33, s62
    s_lshr_b32 s34, s34, 16
    s_mul_i32 s35, s34, s51
    s_sub_u32 s35, s33, s35
    s_mul_i32 s34, s34, s60
    s_lshl_b32 s33, s46, 1
    s_add_u32 s34, s34, s33
    s_mul_i32 s34, s34, s51
    s_add_u32 s34, s34, s35
    s_lshl_b32 s34, s34, 10
    s_add_u32 s53, s34, s61

    s_lshl_b32 s33, s45, 2
    s_add_u32 s33, s33, 2
    s_mul_i32 s34, s33, s62
    s_lshr_b32 s34, s34, 16
    s_mul_i32 s35, s34, s51
    s_sub_u32 s35, s33, s35
    s_mul_i32 s34, s34, s60
    s_lshl_b32 s33, s46, 1
    s_add_u32 s34, s34, s33
    s_mul_i32 s34, s34, s51
    s_add_u32 s34, s34, s35
    s_lshl_b32 s34, s34, 10
    s_add_u32 s54, s34, s61

    s_lshl_b32 s33, s45, 2
    s_add_u32 s33, s33, 3
    s_mul_i32 s34, s33, s62
    s_lshr_b32 s34, s34, 16
    s_mul_i32 s35, s34, s51
    s_sub_u32 s35, s33, s35
    s_mul_i32 s34, s34, s60
    s_lshl_b32 s33, s46, 1
    s_add_u32 s34, s34, s33
    s_mul_i32 s34, s34, s51
    s_add_u32 s34, s34, s35
    s_lshl_b32 s34, s34, 10
    s_add_u32 s55, s34, s61

    s_lshl_b32 s34, s45, 9
    s_add_u32 s57, s34, s32
    s_cmp_ge_u32 s3, 4
    s_cbranch_scc1 M_W4PRE
    s_waitcnt vmcnt(0)
M_PKRET:
    ds_read_b64_tr_b16 v[32:33], v28 offset:0
    ds_read_b64_tr_b16 v[34:35], v28 offset:512
    ds_read_b64_tr_b16 v[36:37], v28 offset:32
    ds_read_b64_tr_b16 v[38:39], v28 offset:544
    ds_read_b64_tr_b16 v[40:41], v28 offset:64
    ds_read_b64_tr_b16 v[42:43], v28 offset:576
    ds_read_b64_tr_b16 v[44:45], v28 offset:96
    ds_read_b64_tr_b16 v[46:47], v28 offset:608
    ds_read_b64_tr_b16 v[48:49], v28 offset:2048
    ds_read_b64_tr_b16 v[50:51], v28 offset:2560
    ds_read_b64_tr_b16 v[52:53], v28 offset:2080
    ds_read_b64_tr_b16 v[54:55], v28 offset:2592
    ds_read_b64_tr_b16 v[56:57], v28 offset:2112
    ds_read_b64_tr_b16 v[58:59], v28 offset:2624
    ds_read_b64_tr_b16 v[60:61], v28 offset:2144
    ds_read_b64_tr_b16 v[62:63], v28 offset:2656
    v_mov_b32 v16, 0
    v_mov_b32 v17, 0
    v_mov_b32 v18, 0
    v_mov_b32 v19, 0
    s_waitcnt lgkmcnt(0)
    buffer_store_dwordx4 v[32:35], v1, s[92:95], s52 offen sc1
    s_add_u32 s52, s52, s56
    v_dot2_f32_bf16 v16, v32, s43, v16
    v_dot2_f32_bf16 v16, v33, s43, v16
    v_dot2_f32_bf16 v16, v34, s43, v16
    v_dot2_f32_bf16 v16, v35, s43, v16
    buffer_store_dwordx4 v[36:39], v1, s[92:95], s53 offen sc1
    s_add_u32 s53, s53, s56
    v_dot2_f32_bf16 v17, v36, s43, v17
    v_dot2_f32_bf16 v17, v37, s43, v17
    v_dot2_f32_bf16 v17, v38, s43, v17
    v_dot2_f32_bf16 v17, v39, s43, v17
    buffer_store_dwordx4 v[40:43], v1, s[92:95], s54 offen sc1
    s_add_u32 s54, s54, s56
    v_dot2_f32_bf16 v18, v40, s43, v18
    v_dot2_f32_bf16 v18, v41, s43, v18
    v_dot2_f32_bf16 v18, v42, s43, v18
    v_dot2_f32_bf16 v18, v43, s43, v18
    buffer_store_dwordx4 v[44:47], v1, s[92:95], s55 offen sc1
    s_add_u32 s55, s55, s56
    v_dot2_f32_bf16 v19, v44, s43, v19
    v_dot2_f32_bf16 v19, v45, s43, v19
    v_dot2_f32_bf16 v19, v46, s43, v19
    v_dot2_f32_bf16 v19, v47, s43, v19
    buffer_store_dwordx4 v[48:51], v1, s[92:95], s52 offen sc1
    v_dot2_f32_bf16 v16, v48, s43, v16
    v_dot2_f32_bf16 v16, v49, s43, v16
    v_dot2_f32_bf16 v16, v50, s43, v16
    v_dot2_f32_bf16 v16, v51, s43, v16
    buffer_store_dwordx4 v[52:55], v1, s[92:95], s53 offen sc1
    v_dot2_f32_bf16 v17, v52, s43, v17
    v_dot2_f32_bf16 v17, v53, s43, v17
    v_dot2_f32_bf16 v17, v54, s43, v17
    v_dot2_f32_bf16 v17, v55, s43, v17
    buffer_store_dwordx4 v[56:59], v1, s[92:95], s54 offen sc1
    v_dot2_f32_bf16 v18, v56, s43, v18
    v_dot2_f32_bf16 v18, v57, s43, v18
    v_dot2_f32_bf16 v18, v58, s43, v18
    v_dot2_f32_bf16 v18, v59, s43, v18
    buffer_store_dwordx4 v[60:63], v1, s[92:95], s55 offen sc1
    v_dot2_f32_bf16 v19, v60, s43, v19
    v_dot2_f32_bf16 v19, v61, s43, v19
    v_dot2_f32_bf16 v19, v62, s43, v19
    v_dot2_f32_bf16 v19, v63, s43, v19
    s_nop 2
    v_mov_b32 v20, v16
    v_mov_b32 v21, v17
    v_mov_b32 v22, v18
    v_mov_b32 v23, v19
    s_nop 1
    v_permlane32_swap_b32 v16, v20
    v_permlane32_swap_b32 v17, v21
    v_permlane32_swap_b32 v18, v22
    v_permlane32_swap_b32 v19, v23
    s_nop 1
    v_add_f32 v16, v16, v20
    v_add_f32 v17, v17, v21
    v_add_f32 v18, v18, v22
    v_add_f32 v19, v19, v23
    s_cmp_lt_u32 s3, 3
    s_cbranch_scc1 M_NOW3
    v_mov_b32 v246, 153356
    s_mov_b32 s4, 0
LW_19:
    ds_read_b32 v247, v246
    s_add_u32 s4, s4, 1
    s_waitcnt lgkmcnt(0)
    v_cmp_gt_u32 vcc, 1, v247
    s_cmp_gt_u32 s4, 0x400000
    s_cbranch_scc1 LW_19_x
    s_cbranch_vccnz LW_19
LW_19_x:

M_NOW3:
    buffer_atomic_add_f32 v16, v29, s[92:95], s57 offen offset:0 sc1
    buffer_atomic_add_f32 v17, v29, s[92:95], s57 offen offset:128 sc1
    buffer_atomic_add_f32 v18, v29, s[92:95], s57 offen offset:256 sc1
    buffer_atomic_add_f32 v19, v29, s[92:95], s57 offen offset:384 sc1
    s_waitcnt vmcnt(0)
    s_cmp_lt_u32 s3, 3
    s_cbranch_scc1 M_ARRW
    v_mov_b32 v246, 153380
    v_mov_b32 v247, 1
    s_mov_b64 exec, 1
    ds_add_rtn_u32 v247, v246, v247
    s_waitcnt lgkmcnt(0)
    v_readfirstlane_b32 s4, v247
    s_mov_b64 exec, -1
    s_cmp_lg_u32 s4, 4
    s_cbranch_scc1 M_P2

    v_mov_b32 v248, 8267904
    v_mov_b32 v249, 1
    s_mov_b64 exec, 1
    buffer_atomic_add v249, v248, s[92:95], 0 offen sc1
    s_mov_b64 exec, -1

    s_branch M_P2
M_ARRW:
    v_mov_b32 v246, 153384
    v_mov_b32 v247, 1
    s_mov_b64 exec, 1
    ds_add_rtn_u32 v247, v246, v247
    s_waitcnt lgkmcnt(0)
    v_readfirstlane_b32 s4, v247
    s_mov_b64 exec, -1
    s_cmp_lg_u32 s4, 2
    s_cbranch_scc1 M_W2END

    v_mov_b32 v246, 153348
    s_mov_b32 s4, 0
LW_20:
    ds_read_b32 v247, v246
    s_add_u32 s4, s4, 1
    s_waitcnt lgkmcnt(0)
    v_cmp_gt_u32 vcc, 1, v247
    s_cmp_gt_u32 s4, 0x400000
    s_cbranch_scc1 LW_20_x
    s_cbranch_vccnz LW_20
LW_20_x:

    s_lshr_b32 s38, s2, 5
    s_lshl_b32 s38, s38, 10
    s_add_u32 s38, s38, 8380544
    v_mov_b32 v248, s38
    v_mov_b32 v249, 1
    s_mov_b64 exec, 1
    buffer_atomic_add v249, v248, s[92:95], 0 offen sc0 sc1
    s_waitcnt vmcnt(0)
    v_readfirstlane_b32 s4, v249
    s_mov_b64 exec, -1
    s_nop 0
    s_cmp_lg_u32 s4, 11
    s_cbranch_scc1 M_W2END

    v_mov_b32 v248, 160
    v_mov_b32 v249, 1
    s_mov_b64 exec, 1
    buffer_atomic_add v249, v248, s[96:99], 0 offen sc0 sc1
    s_waitcnt vmcnt(0)
    v_readfirstlane_b32 s4, v249
    s_mov_b64 exec, -1
    s_and_b32 s4, s4, 7
    s_cmp_lg_u32 s4, 7
    s_cbranch_scc1 M_W2END

    v_mov_b32 v251, 1
    v_lshlrev_b32 v250, 10, v0
    v_add_u32 v250, 8380800, v250
    s_mov_b64 exec, 0xff
    buffer_store_dword v251, v250, s[92:95], 0 offen sc1
    s_mov_b64 exec, -1

M_W2END:
    s_cmp_lg_u32 s3, 0
    s_cbranch_scc1 M_P2
    v_mov_b32 v246, 153348
    s_mov_b32 s4, 0
LW_21:
    ds_read_b32 v247, v246
    s_add_u32 s4, s4, 1
    s_waitcnt lgkmcnt(0)
    v_cmp_gt_u32 vcc, 1, v247
    s_cmp_gt_u32 s4, 0x400000
    s_cbranch_scc1 LW_21_x
    s_cbranch_vccnz LW_21
LW_21_x:

    s_lshr_b32 s4, s2, 5
    s_lshl_b32 s4, s4, 10
    s_add_u32 s4, s4, 8380800
    v_mov_b32 v247, s4
    s_mov_b64 exec, 1
    s_mov_b32 s4, 0
POLL_22:
    buffer_load_dword v252, v247, s[92:95], 0 offen sc1
    s_add_u32 s4, s4, 1
    s_waitcnt vmcnt(0)
    v_cmp_gt_u32 vcc, 1, v252
    s_cmp_gt_u32 s4, 0x40000
    s_cbranch_scc1 POLL_22_x

    s_cbranch_vccnz POLL_22
POLL_22_x:
    s_mov_b64 exec, -1

    v_mov_b32 v246, 153388
    v_mov_b32 v247, 1
    ds_write_b32 v246, v247

M_P2:
    s_barrier
M3_START:

    v_mov_b32 v246, 153404
    s_mov_b32 s4, 0
LW_23:
    ds_read_b32 v247, v246
    s_add_u32 s4, s4, 1
    s_waitcnt lgkmcnt(0)
    v_cmp_gt_u32 vcc, 1, v247
    s_cmp_gt_u32 s4, 0x400000
    s_cbranch_scc1 LW_23_x
    s_cbranch_vccnz LW_23
LW_23_x:

    v_readfirstlane_b32 s91, v247
    s_nop 0
    s_sub_u32 s91, s91, 1
    s_and_b32 s8, s91, 7
    s_lshr_b32 s5, s91, 3
    s_and_b32 s6, s8, 3
    s_lshl_b32 s6, s6, 2
    s_and_b32 s7, s5, 3
    s_add_u32 s6, s6, s7
    s_lshr_b32 s7, s8, 2
    s_lshl_b32 s7, s7, 3
    s_lshr_b32 s8, s5, 2
    s_add_u32 s7, s7, s8
    v_mov_b32 v2, v0
    v_lshlrev_b32 v4, 4, v2
    v_lshrrev_b32 v5, 4, v2

    s_cmp_lt_u32 s3, 4
    s_cbranch_scc1 M3_CONS

    s_sub_u32 s9, s3, 4
    s_mul_i32 s33, s9, 49152
    s_mul_i32 s8, s7, 192
    s_add_u32 s33, s33, s8
    s_mul_i32 s30, s9, 3072

    s_mov_b32 s16, s78
    s_mov_b32 s17, s79
    s_mov_b32 s18, 1966080
    s_mov_b32 s19, 0x20000
    s_mov_b32 s24, s80
    s_mov_b32 s25, s81
    s_mov_b32 s26, 1966080
    s_mov_b32 s27, 0x20000
    v_add_u32 v13, 0, v2
    v_mul_u32_u24 v14, 171, v13
    v_lshrrev_b32 v14, 11, v14
    v_mul_u32_u24 v15, 12, v14
    v_sub_u32 v13, v13, v15
    v_mul_u32_u24 v14, 3072, v14
    v_lshl_add_u32 v52, v13, 4, v14

    v_add_u32 v13, 64, v2
    v_mul_u32_u24 v14, 171, v13
    v_lshrrev_b32 v14, 11, v14
    v_mul_u32_u24 v15, 12, v14
    v_sub_u32 v13, v13, v15
    v_mul_u32_u24 v14, 3072, v14
    v_lshl_add_u32 v53, v13, 4, v14

    v_add_u32 v53, 4294966272, v53
    v_add_u32 v13, 128, v2
    v_mul_u32_u24 v14, 171, v13
    v_lshrrev_b32 v14, 11, v14
    v_mul_u32_u24 v15, 12, v14
    v_sub_u32 v13, v13, v15
    v_mul_u32_u24 v14, 3072, v14
    v_lshl_add_u32 v54, v13, 4, v14

    v_add_u32 v54, 4294965248, v54
    s_mov_b32 s36, 0
    s_add_u32 m0, s36, s30
    s_nop 0
    buffer_load_dwordx4 v52, s[16:19], s33 offen offset:0 lds
    buffer_load_dwordx4 v53, s[16:19], s33 offen offset:1024 lds
    buffer_load_dwordx4 v54, s[16:19], s33 offen offset:2048 lds
    s_add_u32 m0, m0, 12320
    s_nop 0
    buffer_load_dwordx4 v52, s[24:27], s33 offen offset:0 lds
    buffer_load_dwordx4 v53, s[24:27], s33 offen offset:1024 lds
    buffer_load_dwordx4 v54, s[24:27], s33 offen offset:2048 lds
    s_add_u32 s33, s33, 196608
    s_mov_b32 s36, 41216
    s_add_u32 m0, s36, s30
    s_nop 0
    buffer_load_dwordx4 v52, s[16:19], s33 offen offset:0 lds
    buffer_load_dwordx4 v53, s[16:19], s33 offen offset:1024 lds
    buffer_load_dwordx4 v54, s[16:19], s33 offen offset:2048 lds
    s_add_u32 m0, m0, 12320
    s_nop 0
    buffer_load_dwordx4 v52, s[24:27], s33 offen offset:0 lds
    buffer_load_dwordx4 v53, s[24:27], s33 offen offset:1024 lds
    buffer_load_dwordx4 v54, s[24:27], s33 offen offset:2048 lds
    s_add_u32 s33, s33, 196608
    s_mov_b32 s36, 82432
    s_add_u32 m0, s36, s30
    s_nop 0
    buffer_load_dwordx4 v52, s[16:19], s33 offen offset:0 lds
    buffer_load_dwordx4 v53, s[16:19], s33 offen offset:1024 lds
    buffer_load_dwordx4 v54, s[16:19], s33 offen offset:2048 lds
    s_add_u32 m0, m0, 12320
    s_nop 0
    buffer_load_dwordx4 v52, s[24:27], s33 offen offset:0 lds
    buffer_load_dwordx4 v53, s[24:27], s33 offen offset:1024 lds
    buffer_load_dwordx4 v54, s[24:27], s33 offen offset:2048 lds
    s_add_u32 s33, s33, 196608
    s_lshl_b32 s8, s6, 8
    s_add_u32 s8, s8, 8388608
    s_add_u32 s20, s88, s8
    s_addc_u32 s21, s89, 0
    s_mov_b32 s22, 2617600
    s_mov_b32 s23, 0x20000
    v_and_b32 v6, 15, v2
    v_lshlrev_b32 v7, 2, v5
    v_xor_b32 v6, v6, v7
    v_lshlrev_b32 v6, 4, v6
    v_mul_u32_u24 v7, 4096, v5
    v_add_u32 v6, v7, v6
    s_mul_i32 s34, s9, 65536
    s_lshl_b32 s32, s9, 12
    s_add_u32 s32, s32, 24832
    v_mov_b32 v247, 8267904
    s_lshl_b32 s8, s9, 8
    v_lshl_add_u32 v3, v2, 2, s8
    v_add_u32 v10, 124672, v3
    s_mul_i32 s10, s7, 768
    s_add_u32 s10, s10, 8269824
    s_lshr_b32 s12, s7, 1
    s_mul_i32 s8, s12, 245760
    s_add_u32 s8, s8, 12582912
    s_mul_i32 s12, s3, 30720
    s_add_u32 s31, s8, s12
    s_mul_i32 s12, s9, 10240
    s_add_u32 s29, s8, s12
    s_lshl_b32 s12, s6, 10
    s_add_u32 s11, s12, 8282112
    s_lshl_b32 s13, s6, 7
    s_add_u32 s13, s13, 8260868
    v_mov_b32 v245, s13
    v_mov_b32 v244, 1
    s_mul_i32 s14, s9, 10240
    v_add_u32 v246, -4, v247
    s_mul_i32 s39, s7, 40
    s_mul_i32 s41, s9, 10
    s_add_u32 s39, s39, s41
    s_mul_i32 s39, s39, 4096
    s_lshl_b32 s41, s6, 8
    s_add_u32 s39, s39, s41
    s_add_u32 s39, s39, 8388608
    v_mul_u32_u24 v11, 4096, v5
    v_and_b32 v12, 15, v2
    v_lshl_add_u32 v11, v12, 4, v11
    v_cmp_gt_u32 vcc, 2, v5
    v_mov_b32 v13, 0x40000000
    s_add_u32 s41, s39, 16384
    s_add_u32 s42, s39, 32768
    v_cndmask_b32 v13, v13, v11, vcc
    v_lshlrev_b32 v12, 5, v12
    v_lshl_add_u32 v12, v5, 10, v12
    s_lshl_b32 s8, s9, 12
    s_add_u32 s8, s8, 124672
    v_add_u32 v12, s8, v12

    s_barrier
    s_mov_b32 s36, 0
    s_add_u32 m0, s36, s32
    s_add_u32 s35, s34, 15360
    buffer_load_dwordx4 v6, s[20:23], s34 offen sc1 lds
    buffer_load_dwordx4 v6, s[20:23], s35 offen offset:1024 sc1 lds
    s_add_u32 s35, s35, 15360
    buffer_load_dwordx4 v6, s[20:23], s35 offen offset:2048 sc1 lds
    s_add_u32 s35, s35, 15360
    buffer_load_dwordx4 v6, s[20:23], s35 offen offset:3072 sc1 lds
    s_add_u32 s34, s34, 262144
    s_mov_b32 s36, 41216
    s_add_u32 m0, s36, s32
    s_add_u32 s35, s34, 15360
    buffer_load_dwordx4 v6, s[20:23], s34 offen sc1 lds
    buffer_load_dwordx4 v6, s[20:23], s35 offen offset:1024 sc1 lds
    s_add_u32 s35, s35, 15360
    buffer_load_dwordx4 v6, s[20:23], s35 offen offset:2048 sc1 lds
    s_add_u32 s35, s35, 15360
    buffer_load_dwordx4 v6, s[20:23], s35 offen offset:3072 sc1 lds
    s_add_u32 s34, s34, 262144
    s_mov_b32 s36, 82432
    s_add_u32 m0, s36, s32
    s_add_u32 s35, s34, 15360
    buffer_load_dwordx4 v6, s[20:23], s34 offen sc1 lds
    buffer_load_dwordx4 v6, s[20:23], s35 offen offset:1024 sc1 lds
    s_add_u32 s35, s35, 15360
    buffer_load_dwordx4 v6, s[20:23], s35 offen offset:2048 sc1 lds
    s_add_u32 s35, s35, 15360
    buffer_load_dwordx4 v6, s[20:23], s35 offen offset:3072 sc1 lds
    s_add_u32 s34, s34, 262144
    buffer_load_dwordx4 v[32:35], v11, s[92:95], s39 offen sc1
    buffer_load_dwordx4 v[36:39], v11, s[92:95], s41 offen sc1
    buffer_load_dwordx4 v[40:43], v13, s[92:95], s42 offen sc1

    s_waitcnt vmcnt(11)
    s_barrier
    s_waitcnt vmcnt(7)
    s_barrier
    s_mov_b32 s36, 0
    s_add_u32 m0, s36, s32
    s_add_u32 s35, s34, 15360
    buffer_load_dwordx4 v6, s[20:23], s34 offen sc1 lds
    buffer_load_dwordx4 v6, s[20:23], s35 offen offset:1024 sc1 lds
    s_add_u32 s35, s35, 15360
    buffer_load_dwordx4 v6, s[20:23], s35 offen offset:2048 sc1 lds
    s_add_u32 s35, s35, 15360
    buffer_load_dwordx4 v6, s[20:23], s35 offen offset:3072 sc1 lds
    s_add_u32 s34, s34, 262144
    s_add_u32 m0, s36, s30
    s_nop 0
    buffer_load_dwordx4 v52, s[16:19], s33 offen offset:0 lds
    buffer_load_dwordx4 v53, s[16:19], s33 offen offset:1024 lds
    buffer_load_dwordx4 v54, s[16:19], s33 offen offset:2048 lds
    s_add_u32 m0, m0, 12320
    s_nop 0
    buffer_load_dwordx4 v52, s[24:27], s33 offen offset:0 lds
    buffer_load_dwordx4 v53, s[24:27], s33 offen offset:1024 lds
    buffer_load_dwordx4 v54, s[24:27], s33 offen offset:2048 lds
    s_add_u32 s33, s33, 196608
    s_waitcnt vmcnt(10)
    v_lshlrev_b32 v16, 16, v32
    v_and_b32 v17, s40, v32
    v_mul_f32 v24, v16, v16
    v_mul_f32 v25, v17, v17
    v_lshlrev_b32 v18, 16, v33
    v_and_b32 v19, s40, v33
    v_mul_f32 v26, v18, v18
    v_mul_f32 v27, v19, v19
    v_lshlrev_b32 v20, 16, v34
    v_and_b32 v21, s40, v34
    v_mul_f32 v28, v20, v20
    v_mul_f32 v29, v21, v21
    v_lshlrev_b32 v22, 16, v35
    v_and_b32 v23, s40, v35
    v_mul_f32 v30, v22, v22
    v_mul_f32 v31, v23, v23
    v_lshlrev_b32 v48, 16, v36
    v_and_b32 v49, s40, v36
    v_add_f32 v16, v16, v48
    v_add_f32 v17, v17, v49
    v_fmac_f32 v24, v48, v48
    v_fmac_f32 v25, v49, v49
    v_lshlrev_b32 v50, 16, v37
    v_and_b32 v51, s40, v37
    v_add_f32 v18, v18, v50
    v_add_f32 v19, v19, v51
    v_fmac_f32 v26, v50, v50
    v_fmac_f32 v27, v51, v51
    v_lshlrev_b32 v48, 16, v38
    v_and_b32 v49, s40, v38
    v_add_f32 v20, v20, v48
    v_add_f32 v21, v21, v49
    v_fmac_f32 v28, v48, v48
    v_fmac_f32 v29, v49, v49
    v_lshlrev_b32 v50, 16, v39
    v_and_b32 v51, s40, v39
    v_add_f32 v22, v22, v50
    v_add_f32 v23, v23, v51
    v_fmac_f32 v30, v50, v50
    v_fmac_f32 v31, v51, v51
    v_lshlrev_b32 v48, 16, v40
    v_and_b32 v49, s40, v40
    v_add_f32 v16, v16, v48
    v_add_f32 v17, v17, v49
    v_fmac_f32 v24, v48, v48
    v_fmac_f32 v25, v49, v49
    v_lshlrev_b32 v50, 16, v41
    v_and_b32 v51, s40, v41
    v_add_f32 v18, v18, v50
    v_add_f32 v19, v19, v51
    v_fmac_f32 v26, v50, v50
    v_fmac_f32 v27, v51, v51
    v_lshlrev_b32 v48, 16, v42
    v_and_b32 v49, s40, v42
    v_add_f32 v20, v20, v48
    v_add_f32 v21, v21, v49
    v_fmac_f32 v28, v48, v48
    v_fmac_f32 v29, v49, v49
    v_lshlrev_b32 v50, 16, v43
    v_and_b32 v51, s40, v43
    v_add_f32 v22, v22, v50
    v_add_f32 v23, v23, v51
    v_fmac_f32 v30, v50, v50
    v_fmac_f32 v31, v51, v51
    ds_write_b128 v12, v[16:19]
    ds_write_b128 v12, v[20:23] offset:16
    ds_write_b128 v12, v[24:27] offset:512
    ds_write_b128 v12, v[28:31] offset:528
    s_waitcnt lgkmcnt(0)

    s_barrier
    s_mov_b32 s36, 41216
    s_add_u32 m0, s36, s32
    s_add_u32 s35, s34, 15360
    buffer_load_dwordx4 v6, s[20:23], s34 offen sc1 lds
    buffer_load_dwordx4 v6, s[20:23], s35 offen offset:1024 sc1 lds
    s_add_u32 s35, s35, 15360
    buffer_load_dwordx4 v6, s[20:23], s35 offen offset:2048 sc1 lds
    s_add_u32 s35, s35, 15360
    buffer_load_dwordx4 v6, s[20:23], s35 offen offset:3072 sc1 lds
    s_add_u32 s34, s34, 262144
    s_add_u32 m0, s36, s30
    s_nop 0
    buffer_load_dwordx4 v52, s[16:19], s33 offen offset:0 lds
    buffer_load_dwordx4 v53, s[16:19], s33 offen offset:1024 lds
    buffer_load_dwordx4 v54, s[16:19], s33 offen offset:2048 lds
    s_add_u32 m0, m0, 12320
    s_nop 0
    buffer_load_dwordx4 v52, s[24:27], s33 offen offset:0 lds
    buffer_load_dwordx4 v53, s[24:27], s33 offen offset:1024 lds
    buffer_load_dwordx4 v54, s[24:27], s33 offen offset:2048 lds
    s_add_u32 s33, s33, 196608
    ds_read_b32 v16, v10 offset:0
    ds_read_b32 v17, v10 offset:1024
    ds_read_b32 v18, v10 offset:2048
    ds_read_b32 v19, v10 offset:3072
    ds_read_b32 v20, v10 offset:4096
    ds_read_b32 v21, v10 offset:5120
    ds_read_b32 v22, v10 offset:6144
    ds_read_b32 v23, v10 offset:7168
    ds_read_b32 v24, v10 offset:8192
    ds_read_b32 v25, v10 offset:9216
    ds_read_b32 v26, v10 offset:10240
    ds_read_b32 v27, v10 offset:11264
    ds_read_b32 v28, v10 offset:12288
    ds_read_b32 v29, v10 offset:13312
    ds_read_b32 v30, v10 offset:14336
    ds_read_b32 v31, v10 offset:15360
    s_waitcnt lgkmcnt(0)
    v_add_f32 v16, v16, v24
    v_add_f32 v17, v17, v25
    v_add_f32 v18, v18, v26
    v_add_f32 v19, v19, v27
    v_add_f32 v20, v20, v28
    v_add_f32 v21, v21, v29
    v_add_f32 v22, v22, v30
    v_add_f32 v23, v23, v31
    v_add_f32 v16, v16, v20
    v_add_f32 v17, v17, v21
    v_add_f32 v18, v18, v22
    v_add_f32 v19, v19, v23
    v_add_f32 v16, v16, v18
    v_add_f32 v17, v17, v19
    v_add_f32 v16, v16, v17
    buffer_atomic_add_f32 v16, v3, s[92:95], s11 offen sc1
    s_waitcnt vmcnt(11)
    s_barrier
    s_mov_b32 s36, 82432
    s_add_u32 m0, s36, s32
    s_add_u32 s35, s34, 15360
    buffer_load_dwordx4 v6, s[20:23], s34 offen sc1 lds
    buffer_load_dwordx4 v6, s[20:23], s35 offen offset:1024 sc1 lds
    s_add_u32 s35, s35, 15360
    buffer_load_dwordx4 v6, s[20:23], s35 offen offset:2048 sc1 lds
    s_add_u32 s35, s35, 15360
    buffer_load_dwordx4 v6, s[20:23], s35 offen offset:3072 sc1 lds
    s_add_u32 s34, s34, 262144
    s_add_u32 m0, s36, s30
    s_nop 0
    buffer_load_dwordx4 v52, s[16:19], s33 offen offset:0 lds
    buffer_load_dwordx4 v53, s[16:19], s33 offen offset:1024 lds
    buffer_load_dwordx4 v54, s[16:19], s33 offen offset:2048 lds
    s_add_u32 m0, m0, 12320
    s_nop 0
    buffer_load_dwordx4 v52, s[24:27], s33 offen offset:0 lds
    buffer_load_dwordx4 v53, s[24:27], s33 offen offset:1024 lds
    buffer_load_dwordx4 v54, s[24:27], s33 offen offset:2048 lds
    s_add_u32 s33, s33, 196608
    s_waitcnt vmcnt(11)
    s_barrier
    s_mov_b32 s36, 0
    s_add_u32 m0, s36, s32
    s_add_u32 s35, s34, 15360
    buffer_load_dwordx4 v6, s[20:23], s34 offen sc1 lds
    buffer_load_dwordx4 v6, s[20:23], s35 offen offset:1024 sc1 lds
    s_add_u32 s35, s35, 15360
    buffer_load_dwordx4 v6, s[20:23], s35 offen offset:2048 sc1 lds
    s_add_u32 s35, s35, 15360
    buffer_load_dwordx4 v6, s[20:23], s35 offen offset:3072 sc1 lds
    s_add_u32 s34, s34, 262144
    s_add_u32 m0, s36, s30
    s_nop 0
    buffer_load_dwordx4 v52, s[16:19], s33 offen offset:0 lds
    buffer_load_dwordx4 v53, s[16:19], s33 offen offset:1024 lds
    buffer_load_dwordx4 v54, s[16:19], s33 offen offset:2048 lds
    s_add_u32 m0, m0, 12320
    s_nop 0
    buffer_load_dwordx4 v52, s[24:27], s33 offen offset:0 lds
    buffer_load_dwordx4 v53, s[24:27], s33 offen offset:1024 lds
    buffer_load_dwordx4 v54, s[24:27], s33 offen offset:2048 lds
    s_add_u32 s33, s33, 196608
    buffer_load_dword v252, v247, s[92:95], 0 offen sc1
    s_waitcnt vmcnt(11)
    s_barrier
    s_mov_b32 s36, 41216
    s_add_u32 m0, s36, s32
    s_add_u32 s35, s34, 15360
    buffer_load_dwordx4 v6, s[20:23], s34 offen sc1 lds
    buffer_load_dwordx4 v6, s[20:23], s35 offen offset:1024 sc1 lds
    s_add_u32 s35, s35, 15360
    buffer_load_dwordx4 v6, s[20:23], s35 offen offset:2048 sc1 lds
    s_add_u32 s35, s35, 15360
    buffer_load_dwordx4 v6, s[20:23], s35 offen offset:3072 sc1 lds
    s_add_u32 s34, s34, 262144
    s_add_u32 m0, s36, s30
    s_nop 0
    buffer_load_dwordx4 v52, s[16:19], s33 offen offset:0 lds
    buffer_load_dwordx4 v53, s[16:19], s33 offen offset:1024 lds
    buffer_load_dwordx4 v54, s[16:19], s33 offen offset:2048 lds
    s_add_u32 m0, m0, 12320
    s_nop 0
    buffer_load_dwordx4 v52, s[24:27], s33 offen offset:0 lds
    buffer_load_dwordx4 v53, s[24:27], s33 offen offset:1024 lds
    buffer_load_dwordx4 v54, s[24:27], s33 offen offset:2048 lds
    s_add_u32 s33, s33, 196608
    s_cmp_lg_u32 s3, 4
    s_cselect_b64 exec, 0, 1
    s_cbranch_scc1 M3P_NOAT
    buffer_atomic_add v244, v245, s[92:95], 0 offen sc1
M3P_NOAT:
    s_mov_b64 exec, -1

    s_waitcnt vmcnt(11)
    s_barrier
    s_mov_b32 s36, 82432
    s_add_u32 m0, s36, s32
    s_add_u32 s35, s34, 15360
    buffer_load_dwordx4 v6, s[20:23], s34 offen sc1 lds
    buffer_load_dwordx4 v6, s[20:23], s35 offen offset:1024 sc1 lds
    s_add_u32 s35, s35, 15360
    buffer_load_dwordx4 v6, s[20:23], s35 offen offset:2048 sc1 lds
    s_add_u32 s35, s35, 15360
    buffer_load_dwordx4 v6, s[20:23], s35 offen offset:3072 sc1 lds
    s_add_u32 s34, s34, 262144
    s_add_u32 m0, s36, s30
    s_nop 0
    buffer_load_dwordx4 v52, s[16:19], s33 offen offset:0 lds
    buffer_load_dwordx4 v53, s[16:19], s33 offen offset:1024 lds
    buffer_load_dwordx4 v54, s[16:19], s33 offen offset:2048 lds
    s_add_u32 m0, m0, 12320
    s_nop 0
    buffer_load_dwordx4 v52, s[24:27], s33 offen offset:0 lds
    buffer_load_dwordx4 v53, s[24:27], s33 offen offset:1024 lds
    buffer_load_dwordx4 v54, s[24:27], s33 offen offset:2048 lds
    s_add_u32 s33, s33, 196608
    s_waitcnt vmcnt(20)
    v_cmp_gt_u32 vcc, 0x60, v252
    s_cbranch_vccz M3P_FLAGOK
    s_mov_b64 exec, 1
    s_mov_b32 s4, 0
POLL_24:
    buffer_load_dword v252, v247, s[92:95], 0 offen sc1
    s_add_u32 s4, s4, 1
    s_waitcnt vmcnt(0)
    v_cmp_gt_u32 vcc, 96, v252
    s_cmp_gt_u32 s4, 0x40000
    s_cbranch_scc1 POLL_24_x

    s_cbranch_vccnz POLL_24
POLL_24_x:
    s_mov_b64 exec, -1

M3P_FLAGOK:
    buffer_load_dword v60, v3, s[92:95], s10 offen sc1
    s_waitcnt vmcnt(11)
    s_barrier
    s_mov_b32 s36, 0
    s_add_u32 m0, s36, s32
    s_add_u32 s35, s34, 15360
    buffer_load_dwordx4 v6, s[20:23], s34 offen sc1 lds
    buffer_load_dwordx4 v6, s[20:23], s35 offen offset:1024 sc1 lds
    s_add_u32 s35, s35, 15360
    buffer_load_dwordx4 v6, s[20:23], s35 offen offset:2048 sc1 lds
    s_add_u32 s35, s35, 15360
    buffer_load_dwordx4 v6, s[20:23], s35 offen offset:3072 sc1 lds
    s_add_u32 s34, s34, 262144
    s_add_u32 m0, s36, s30
    s_nop 0
    buffer_load_dwordx4 v52, s[16:19], s33 offen offset:0 lds
    buffer_load_dwordx4 v53, s[16:19], s33 offen offset:1024 lds
    buffer_load_dwordx4 v54, s[16:19], s33 offen offset:2048 lds
    s_add_u32 m0, m0, 12320
    s_nop 0
    buffer_load_dwordx4 v52, s[24:27], s33 offen offset:0 lds
    buffer_load_dwordx4 v53, s[24:27], s33 offen offset:1024 lds
    buffer_load_dwordx4 v54, s[24:27], s33 offen offset:2048 lds
    s_add_u32 s33, s33, 196608
    buffer_load_dword v251, v245, s[92:95], 0 offen sc1
    s_waitcnt vmcnt(12)
    s_barrier
    s_waitcnt vmcnt(0)
    v_cmp_gt_u32 vcc, 16, v251
    s_cbranch_vccz M3P_CNTOK
    s_mov_b64 exec, 1
    s_mov_b32 s4, 0
POLL_25:
    buffer_load_dword v252, v245, s[92:95], 0 offen sc1
    s_add_u32 s4, s4, 1
    s_waitcnt vmcnt(0)
    v_cmp_gt_u32 vcc, 16, v252
    s_cmp_gt_u32 s4, 0x40000
    s_cbranch_scc1 POLL_25_x

    s_cbranch_vccnz POLL_25
POLL_25_x:
    s_mov_b64 exec, -1

M3P_CNTOK:
    buffer_load_dword v16, v3, s[92:95], s11 offen sc1
    v_add_u32 v11, 123648, v3
    ds_write_b32 v11, v60
    s_add_u32 m0, s14, 41216
    s_add_u32 s15, s29, 4096
    s_add_u32 s28, s29, 8192
    buffer_load_dwordx4 v4, s[92:95], s29 offen offset:0 sc1 lds
    buffer_load_dwordx4 v4, s[92:95], s29 offen offset:1024 sc1 lds
    buffer_load_dwordx4 v4, s[92:95], s29 offen offset:2048 sc1 lds
    buffer_load_dwordx4 v4, s[92:95], s29 offen offset:3072 sc1 lds
    s_add_u32 m0, m0, 4096
    s_nop 0
    buffer_load_dwordx4 v4, s[92:95], s15 offen offset:0 sc1 lds
    buffer_load_dwordx4 v4, s[92:95], s15 offen offset:1024 sc1 lds
    buffer_load_dwordx4 v4, s[92:95], s15 offen offset:2048 sc1 lds
    buffer_load_dwordx4 v4, s[92:95], s15 offen offset:3072 sc1 lds
    s_add_u32 m0, m0, 4096
    s_nop 0
    buffer_load_dwordx4 v4, s[92:95], s28 offen offset:0 sc1 lds
    buffer_load_dwordx4 v4, s[92:95], s28 offen offset:1024 sc1 lds
    s_add_u32 s29, s29, 40960
    s_barrier
    s_waitcnt vmcnt(10)
    v_mul_f32 v16, 0x3acccccd, v16
    v_add_u32 v11, 153408, v3
    ds_write_b32 v11, v16
    s_waitcnt lgkmcnt(0)
    s_add_u32 m0, s14, 82432
    s_add_u32 s15, s29, 4096
    s_add_u32 s28, s29, 8192
    buffer_load_dwordx4 v4, s[92:95], s29 offen offset:0 sc1 lds
    buffer_load_dwordx4 v4, s[92:95], s29 offen offset:1024 sc1 lds
    buffer_load_dwordx4 v4, s[92:95], s29 offen offset:2048 sc1 lds
    buffer_load_dwordx4 v4, s[92:95], s29 offen offset:3072 sc1 lds
    s_add_u32 m0, m0, 4096
    s_nop 0
    buffer_load_dwordx4 v4, s[92:95], s15 offen offset:0 sc1 lds
    buffer_load_dwordx4 v4, s[92:95], s15 offen offset:1024 sc1 lds
    buffer_load_dwordx4 v4, s[92:95], s15 offen offset:2048 sc1 lds
    buffer_load_dwordx4 v4, s[92:95], s15 offen offset:3072 sc1 lds
    s_add_u32 m0, m0, 4096
    s_nop 0
    buffer_load_dwordx4 v4, s[92:95], s28 offen offset:0 sc1 lds
    buffer_load_dwordx4 v4, s[92:95], s28 offen offset:1024 sc1 lds
    s_add_u32 s29, s29, 40960
    s_barrier
    s_add_u32 m0, s14, 0
    s_add_u32 s15, s29, 4096
    s_add_u32 s28, s29, 8192
    buffer_load_dwordx4 v4, s[92:95], s29 offen offset:0 sc1 lds
    buffer_load_dwordx4 v4, s[92:95], s29 offen offset:1024 sc1 lds
    buffer_load_dwordx4 v4, s[92:95], s29 offen offset:2048 sc1 lds
    buffer_load_dwordx4 v4, s[92:95], s29 offen offset:3072 sc1 lds
    s_add_u32 m0, m0, 4096
    s_nop 0
    buffer_load_dwordx4 v4, s[92:95], s15 offen offset:0 sc1 lds
    buffer_load_dwordx4 v4, s[92:95], s15 offen offset:1024 sc1 lds
    buffer_load_dwordx4 v4, s[92:95], s15 offen offset:2048 sc1 lds
    buffer_load_dwordx4 v4, s[92:95], s15 offen offset:3072 sc1 lds
    s_add_u32 m0, m0, 4096
    s_nop 0
    buffer_load_dwordx4 v4, s[92:95], s28 offen offset:0 sc1 lds
    buffer_load_dwordx4 v4, s[92:95], s28 offen offset:1024 sc1 lds
    s_add_u32 s29, s29, 40960
    s_lshr_b32 s10, s7, 1
    s_and_b32 s11, s7, 1
    s_lshl_b32 s8, s6, 1
    s_add_u32 s11, s11, s8
    s_branch M4_START2

M3_CONS:
    s_and_b32 s37, s3, 1
    s_lshr_b32 s38, s3, 1
    v_bfe_u32 v9, v2, 2, 2
    v_lshrrev_b32 v10, 5, v2
    v_and_b32 v12, 1, v5
    v_and_b32 v13, 3, v2
    v_mul_u32_u24 v7, 12320, v12
    v_lshl_add_u32 v8, v10, 3, v9
    v_mul_u32_u24 v8, 192, v8
    v_add_u32 v7, v7, v8
    v_lshl_add_u32 v7, v13, 3, v7
    s_mul_i32 s39, s37, 96
    v_add_u32 v7, s39, v7
    v_lshl_add_u32 v11, v10, 3, v9
    v_lshlrev_b32 v11, 8, v11
    v_lshl_add_u32 v11, v12, 5, v11
    v_lshl_add_u32 v11, v13, 3, v11
    v_add_u32 v11, 24832, v11
    s_lshl_b32 s39, s38, 1
    v_xor_b32 v12, s39, v9
    v_xor_b32 v13, 1, v12
    v_lshl_add_u32 v9, v12, 6, v11
    v_lshl_add_u32 v10, v13, 6, v11
    s_and_b32 s39, s91, 7
    s_lshl_b32 s39, s39, 7
    s_add_u32 s39, s39, 8331264
    v_lshl_add_u32 v14, v2, 10, s39
    s_cmp_lg_u32 s3, 0
    s_cbranch_scc1 M3_NOPOLL

    s_mov_b64 exec, 0x3ff
    s_mov_b32 s4, 0
POLL_26:
    buffer_load_dword v252, v14, s[92:95], 0 offen sc1
    s_add_u32 s4, s4, 1
    s_waitcnt vmcnt(0)
    v_cmp_gt_u32 vcc, 1, v252
    s_cmp_gt_u32 s4, 0x40000
    s_cbranch_scc1 POLL_26_x

    s_cbranch_vccnz POLL_26
POLL_26_x:
    s_mov_b64 exec, -1

M3_NOPOLL:
    s_barrier
    v_mov_b32 v16, 0
    v_mov_b32 v17, 0
    v_mov_b32 v18, 0
    v_mov_b32 v19, 0
    v_mov_b32 v20, 0
    v_mov_b32 v21, 0
    v_mov_b32 v22, 0
    v_mov_b32 v23, 0
    v_mov_b32 v24, 0
    v_mov_b32 v25, 0
    v_mov_b32 v26, 0
    v_mov_b32 v27, 0
    v_mov_b32 v28, 0
    v_mov_b32 v29, 0
    v_mov_b32 v30, 0
    v_mov_b32 v31, 0
    v_mov_b32 v32, 0
    v_mov_b32 v33, 0
    v_mov_b32 v34, 0
    v_mov_b32 v35, 0
    v_mov_b32 v36, 0
    v_mov_b32 v37, 0
    v_mov_b32 v38, 0
    v_mov_b32 v39, 0
    v_mov_b32 v40, 0
    v_mov_b32 v41, 0
    v_mov_b32 v42, 0
    v_mov_b32 v43, 0
    v_mov_b32 v44, 0
    v_mov_b32 v45, 0
    v_mov_b32 v46, 0
    v_mov_b32 v47, 0
    v_mov_b32 v48, 0
    v_mov_b32 v49, 0
    v_mov_b32 v50, 0
    v_mov_b32 v51, 0
    v_mov_b32 v52, 0
    v_mov_b32 v53, 0
    v_mov_b32 v54, 0
    v_mov_b32 v55, 0
    v_mov_b32 v56, 0
    v_mov_b32 v57, 0
    v_mov_b32 v58, 0
    v_mov_b32 v59, 0
    v_mov_b32 v60, 0
    v_mov_b32 v61, 0
    v_mov_b32 v62, 0
    v_mov_b32 v63, 0
    v_mov_b32 v64, 0
    v_mov_b32 v65, 0
    v_mov_b32 v66, 0
    v_mov_b32 v67, 0
    v_mov_b32 v68, 0
    v_mov_b32 v69, 0
    v_mov_b32 v70, 0
    v_mov_b32 v71, 0
    v_mov_b32 v72, 0
    v_mov_b32 v73, 0
    v_mov_b32 v74, 0
    v_mov_b32 v75, 0
    v_mov_b32 v76, 0
    v_mov_b32 v77, 0
    v_mov_b32 v78, 0
    v_mov_b32 v79, 0
    v_mov_b32 v80, 0
    v_mov_b32 v81, 0
    v_mov_b32 v82, 0
    v_mov_b32 v83, 0
    v_mov_b32 v84, 0
    v_mov_b32 v85, 0
    v_mov_b32 v86, 0
    v_mov_b32 v87, 0
    v_mov_b32 v88, 0
    v_mov_b32 v89, 0
    v_mov_b32 v90, 0
    v_mov_b32 v91, 0
    v_mov_b32 v92, 0
    v_mov_b32 v93, 0
    v_mov_b32 v94, 0
    v_mov_b32 v95, 0
    v_mov_b32 v96, 0
    v_mov_b32 v97, 0
    v_mov_b32 v98, 0
    v_mov_b32 v99, 0
    v_mov_b32 v100, 0
    v_mov_b32 v101, 0
    v_mov_b32 v102, 0
    v_mov_b32 v103, 0
    v_mov_b32 v104, 0
    v_mov_b32 v105, 0
    v_mov_b32 v106, 0
    v_mov_b32 v107, 0
    v_mov_b32 v108, 0
    v_mov_b32 v109, 0
    v_mov_b32 v110, 0
    v_mov_b32 v111, 0
    v_mov_b32 v160, v7
    v_mov_b32 v162, v9
    v_mov_b32 v163, v10
    s_mov_b32 s41, 41216
    s_mov_b32 s42, 0
    s_setprio 1
    s_waitcnt lgkmcnt(0)
    s_barrier

    ds_read_b64_tr_b16 v[116:117], v160 offset:0
    ds_read_b64_tr_b16 v[118:119], v160 offset:768
    ds_read_b64_tr_b16 v[128:129], v162 offset:0
    ds_read_b64_tr_b16 v[130:131], v162 offset:1024
    ds_read_b64_tr_b16 v[132:133], v163 offset:0
    ds_read_b64_tr_b16 v[134:135], v163 offset:1024
    ds_read_b64_tr_b16 v[120:121], v160 offset:32
    ds_read_b64_tr_b16 v[122:123], v160 offset:800
    ds_read_b64_tr_b16 v[124:125], v160 offset:64
    ds_read_b64_tr_b16 v[126:127], v160 offset:832
M3_LOOP:
    s_waitcnt lgkmcnt(0)
    v_mfma_f32_32x32x16_bf16 v[16:31], v[116:119], v[128:131], v[16:31]
    ds_read_b64_tr_b16 v[136:137], v160 offset:3072
    ds_read_b64_tr_b16 v[138:139], v160 offset:3840
    v_mfma_f32_32x32x16_bf16 v[32:47], v[116:119], v[132:135], v[32:47]
    ds_read_b64_tr_b16 v[148:149], v162 offset:4096
    ds_read_b64_tr_b16 v[150:151], v162 offset:5120
    v_mfma_f32_32x32x16_bf16 v[48:63], v[120:123], v[128:131], v[48:63]
    ds_read_b64_tr_b16 v[152:153], v163 offset:4096
    ds_read_b64_tr_b16 v[154:155], v163 offset:5120
    v_mfma_f32_32x32x16_bf16 v[64:79], v[120:123], v[132:135], v[64:79]
    ds_read_b64_tr_b16 v[140:141], v160 offset:3104
    ds_read_b64_tr_b16 v[142:143], v160 offset:3872
    v_mfma_f32_32x32x16_bf16 v[80:95], v[124:127], v[128:131], v[80:95]
    ds_read_b64_tr_b16 v[144:145], v160 offset:3136
    ds_read_b64_tr_b16 v[146:147], v160 offset:3904
    v_mfma_f32_32x32x16_bf16 v[96:111], v[124:127], v[132:135], v[96:111]
    s_waitcnt lgkmcnt(0)
    v_mfma_f32_32x32x16_bf16 v[16:31], v[136:139], v[148:151], v[16:31]
    ds_read_b64_tr_b16 v[116:117], v160 offset:6144
    ds_read_b64_tr_b16 v[118:119], v160 offset:6912
    v_mfma_f32_32x32x16_bf16 v[32:47], v[136:139], v[152:155], v[32:47]
    ds_read_b64_tr_b16 v[128:129], v162 offset:8192
    ds_read_b64_tr_b16 v[130:131], v162 offset:9216
    v_mfma_f32_32x32x16_bf16 v[48:63], v[140:143], v[148:151], v[48:63]
    ds_read_b64_tr_b16 v[132:133], v163 offset:8192
    ds_read_b64_tr_b16 v[134:135], v163 offset:9216
    v_mfma_f32_32x32x16_bf16 v[64:79], v[140:143], v[152:155], v[64:79]
    ds_read_b64_tr_b16 v[120:121], v160 offset:6176
    ds_read_b64_tr_b16 v[122:123], v160 offset:6944
    v_mfma_f32_32x32x16_bf16 v[80:95], v[144:147], v[148:151], v[80:95]
    ds_read_b64_tr_b16 v[124:125], v160 offset:6208
    ds_read_b64_tr_b16 v[126:127], v160 offset:6976
    v_mfma_f32_32x32x16_bf16 v[96:111], v[144:147], v[152:155], v[96:111]
    s_waitcnt lgkmcnt(0)
    v_mfma_f32_32x32x16_bf16 v[16:31], v[116:119], v[128:131], v[16:31]
    ds_read_b64_tr_b16 v[136:137], v160 offset:9216
    ds_read_b64_tr_b16 v[138:139], v160 offset:9984
    v_mfma_f32_32x32x16_bf16 v[32:47], v[116:119], v[132:135], v[32:47]
    ds_read_b64_tr_b16 v[148:149], v162 offset:12288
    ds_read_b64_tr_b16 v[150:151], v162 offset:13312
    v_mfma_f32_32x32x16_bf16 v[48:63], v[120:123], v[128:131], v[48:63]
    ds_read_b64_tr_b16 v[152:153], v163 offset:12288
    ds_read_b64_tr_b16 v[154:155], v163 offset:13312
    v_mfma_f32_32x32x16_bf16 v[64:79], v[120:123], v[132:135], v[64:79]
    ds_read_b64_tr_b16 v[140:141], v160 offset:9248
    ds_read_b64_tr_b16 v[142:143], v160 offset:10016
    v_mfma_f32_32x32x16_bf16 v[80:95], v[124:127], v[128:131], v[80:95]
    ds_read_b64_tr_b16 v[144:145], v160 offset:9280
    ds_read_b64_tr_b16 v[146:147], v160 offset:10048
    v_mfma_f32_32x32x16_bf16 v[96:111], v[124:127], v[132:135], v[96:111]
    v_add_u32 v160, s41, v7
    v_add_u32 v162, s41, v9
    v_add_u32 v163, s41, v10
    s_waitcnt lgkmcnt(0)
    s_barrier

    v_mfma_f32_32x32x16_bf16 v[16:31], v[136:139], v[148:151], v[16:31]
    ds_read_b64_tr_b16 v[116:117], v160 offset:0
    ds_read_b64_tr_b16 v[118:119], v160 offset:768
    ds_read_b64_tr_b16 v[128:129], v162 offset:0
    v_mfma_f32_32x32x16_bf16 v[32:47], v[136:139], v[152:155], v[32:47]
    ds_read_b64_tr_b16 v[130:131], v162 offset:1024
    ds_read_b64_tr_b16 v[132:133], v163 offset:0
    ds_read_b64_tr_b16 v[134:135], v163 offset:1024
    v_mfma_f32_32x32x16_bf16 v[48:63], v[140:143], v[148:151], v[48:63]
    ds_read_b64_tr_b16 v[120:121], v160 offset:32
    ds_read_b64_tr_b16 v[122:123], v160 offset:800
    ds_read_b64_tr_b16 v[124:125], v160 offset:64
    v_mfma_f32_32x32x16_bf16 v[64:79], v[140:143], v[152:155], v[64:79]
    ds_read_b64_tr_b16 v[126:127], v160 offset:832
    s_add_u32 s41, s41, 41216
    s_cmp_eq_u32 s41, 123648
    v_mfma_f32_32x32x16_bf16 v[80:95], v[144:147], v[148:151], v[80:95]
    s_cselect_b32 s41, 0, s41
    s_add_u32 s42, s42, 1
    s_cmp_lt_u32 s42, 10
    v_mfma_f32_32x32x16_bf16 v[96:111], v[144:147], v[152:155], v[96:111]
    s_cbranch_scc1 M3_LOOP
    s_setprio 0
    v_lshrrev_b32 v10, 5, v2
    v_lshlrev_b32 v11, 4, v10
    s_mul_i32 s39, s37, 384
    s_add_u32 s39, s39, 123648
    v_add_u32 v11, s39, v11
    v_and_b32 v13, 31, v2
    s_lshl_b32 s39, s38, 8
    s_add_u32 s39, s39, 153408
    v_lshl_add_u32 v13, v13, 2, s39
    v_and_b32 v12, 1, v5
    v_mul_u32_u24 v12, 49152, v12
    v_lshl_add_u32 v12, v10, 8, v12
    v_and_b32 v14, 15, v2
    v_lshl_add_u32 v12, v14, 4, v12
    s_lshl_b32 s43, s6, 3
    s_lshl_b32 s46, s38, 2
    s_add_u32 s43, s43, s46
    s_mul_i32 s43, s43, 49152
    s_mul_i32 s46, s7, 6
    s_mul_i32 s48, s37, 3
    s_add_u32 s46, s46, s48
    s_lshl_b32 s46, s46, 9
    s_add_u32 s43, s43, s46
    s_add_u32 s43, s43, 14680064
    s_add_u32 s46, s43, 98304
    s_mov_b32 s45, 0x3727c5ac
    s_waitcnt lgkmcnt(0)

    ds_read2_b32 v[164:165], v13 offset0:0 offset1:32
    ds_read2_b32 v[166:167], v13 offset0:128 offset1:160
    ds_read_b128 v[116:119], v11 offset:0
    ds_read_b128 v[120:123], v11 offset:32
    ds_read_b128 v[124:127], v11 offset:64
    ds_read_b128 v[128:131], v11 offset:96
    ds_read_b128 v[132:135], v11 offset:128
    ds_read_b128 v[136:139], v11 offset:160
    ds_read_b128 v[140:143], v11 offset:192
    ds_read_b128 v[144:147], v11 offset:224
    ds_read_b128 v[148:151], v11 offset:256
    ds_read_b128 v[152:155], v11 offset:288
    ds_read_b128 v[156:159], v11 offset:320
    ds_read_b128 v[160:163], v11 offset:352
    s_waitcnt lgkmcnt(12)
    v_fma_f32 v166, -v164, v164, v166
    v_max_f32 v166, 0, v166
    v_add_f32 v166, s45, v166
    v_rcp_f32 v176, v166
    v_sub_f32 v172, 0, v164
    v_sub_f32 v173, 0, v164
    v_mov_b32 v177, v176

    v_fma_f32 v167, -v165, v165, v167
    v_max_f32 v167, 0, v167
    v_add_f32 v167, s45, v167
    v_rcp_f32 v178, v167
    v_sub_f32 v174, 0, v165
    v_sub_f32 v175, 0, v165
    v_mov_b32 v179, v178

    s_waitcnt lgkmcnt(8)
    v_pk_fma_f32 v[16:17], v[172:173], v[116:117], v[16:17]
    v_pk_fma_f32 v[18:19], v[172:173], v[118:119], v[18:19]
    v_pk_fma_f32 v[20:21], v[172:173], v[120:121], v[20:21]
    v_pk_fma_f32 v[22:23], v[172:173], v[122:123], v[22:23]
    v_pk_fma_f32 v[24:25], v[172:173], v[124:125], v[24:25]
    v_pk_fma_f32 v[26:27], v[172:173], v[126:127], v[26:27]
    v_pk_fma_f32 v[28:29], v[172:173], v[128:129], v[28:29]
    v_pk_fma_f32 v[30:31], v[172:173], v[130:131], v[30:31]
    v_max_f32 v16, 0, v16
    v_max_f32 v17, 0, v17
    v_pk_mul_f32 v[24:25], v[176:177], v[24:25]
    v_max_f32 v18, 0, v18
    v_max_f32 v19, 0, v19
    v_pk_mul_f32 v[26:27], v[176:177], v[26:27]
    v_max_f32 v20, 0, v20
    v_max_f32 v21, 0, v21
    v_pk_mul_f32 v[28:29], v[176:177], v[28:29]
    v_max_f32 v22, 0, v22
    v_max_f32 v23, 0, v23
    v_pk_mul_f32 v[30:31], v[176:177], v[30:31]
    v_pk_mul_f32 v[16:17], v[16:17], v[24:25]
    v_pk_mul_f32 v[18:19], v[18:19], v[26:27]
    v_pk_mul_f32 v[20:21], v[20:21], v[28:29]
    v_pk_mul_f32 v[22:23], v[22:23], v[30:31]
    v_cvt_pk_bf16_f32 v206, v16, v17
    v_cvt_pk_bf16_f32 v207, v18, v19
    v_cvt_pk_bf16_f32 v208, v20, v21
    v_cvt_pk_bf16_f32 v209, v22, v23
    buffer_store_dwordx4 v[206:209], v12, s[92:95], s43 offen offset:0 sc1
    v_pk_fma_f32 v[32:33], v[174:175], v[116:117], v[32:33]
    v_pk_fma_f32 v[34:35], v[174:175], v[118:119], v[34:35]
    v_pk_fma_f32 v[36:37], v[174:175], v[120:121], v[36:37]
    v_pk_fma_f32 v[38:39], v[174:175], v[122:123], v[38:39]
    v_pk_fma_f32 v[40:41], v[174:175], v[124:125], v[40:41]
    v_pk_fma_f32 v[42:43], v[174:175], v[126:127], v[42:43]
    v_pk_fma_f32 v[44:45], v[174:175], v[128:129], v[44:45]
    v_pk_fma_f32 v[46:47], v[174:175], v[130:131], v[46:47]
    v_max_f32 v32, 0, v32
    v_max_f32 v33, 0, v33
    v_pk_mul_f32 v[40:41], v[178:179], v[40:41]
    v_max_f32 v34, 0, v34
    v_max_f32 v35, 0, v35
    v_pk_mul_f32 v[42:43], v[178:179], v[42:43]
    v_max_f32 v36, 0, v36
    v_max_f32 v37, 0, v37
    v_pk_mul_f32 v[44:45], v[178:179], v[44:45]
    v_max_f32 v38, 0, v38
    v_max_f32 v39, 0, v39
    v_pk_mul_f32 v[46:47], v[178:179], v[46:47]
    v_pk_mul_f32 v[32:33], v[32:33], v[40:41]
    v_pk_mul_f32 v[34:35], v[34:35], v[42:43]
    v_pk_mul_f32 v[36:37], v[36:37], v[44:45]
    v_pk_mul_f32 v[38:39], v[38:39], v[46:47]
    v_cvt_pk_bf16_f32 v210, v32, v33
    v_cvt_pk_bf16_f32 v211, v34, v35
    v_cvt_pk_bf16_f32 v212, v36, v37
    v_cvt_pk_bf16_f32 v213, v38, v39
    buffer_store_dwordx4 v[210:213], v12, s[92:95], s46 offen offset:0 sc1
    s_waitcnt lgkmcnt(4)
    v_pk_fma_f32 v[48:49], v[172:173], v[132:133], v[48:49]
    v_pk_fma_f32 v[50:51], v[172:173], v[134:135], v[50:51]
    v_pk_fma_f32 v[52:53], v[172:173], v[136:137], v[52:53]
    v_pk_fma_f32 v[54:55], v[172:173], v[138:139], v[54:55]
    v_pk_fma_f32 v[56:57], v[172:173], v[140:141], v[56:57]
    v_pk_fma_f32 v[58:59], v[172:173], v[142:143], v[58:59]
    v_pk_fma_f32 v[60:61], v[172:173], v[144:145], v[60:61]
    v_pk_fma_f32 v[62:63], v[172:173], v[146:147], v[62:63]
    v_max_f32 v48, 0, v48
    v_max_f32 v49, 0, v49
    v_pk_mul_f32 v[56:57], v[176:177], v[56:57]
    v_max_f32 v50, 0, v50
    v_max_f32 v51, 0, v51
    v_pk_mul_f32 v[58:59], v[176:177], v[58:59]
    v_max_f32 v52, 0, v52
    v_max_f32 v53, 0, v53
    v_pk_mul_f32 v[60:61], v[176:177], v[60:61]
    v_max_f32 v54, 0, v54
    v_max_f32 v55, 0, v55
    v_pk_mul_f32 v[62:63], v[176:177], v[62:63]
    v_pk_mul_f32 v[48:49], v[48:49], v[56:57]
    v_pk_mul_f32 v[50:51], v[50:51], v[58:59]
    v_pk_mul_f32 v[52:53], v[52:53], v[60:61]
    v_pk_mul_f32 v[54:55], v[54:55], v[62:63]
    v_cvt_pk_bf16_f32 v214, v48, v49
    v_cvt_pk_bf16_f32 v215, v50, v51
    v_cvt_pk_bf16_f32 v216, v52, v53
    v_cvt_pk_bf16_f32 v217, v54, v55
    buffer_store_dwordx4 v[214:217], v12, s[92:95], s43 offen offset:512 sc1
    v_pk_fma_f32 v[64:65], v[174:175], v[132:133], v[64:65]
    v_pk_fma_f32 v[66:67], v[174:175], v[134:135], v[66:67]
    v_pk_fma_f32 v[68:69], v[174:175], v[136:137], v[68:69]
    v_pk_fma_f32 v[70:71], v[174:175], v[138:139], v[70:71]
    v_pk_fma_f32 v[72:73], v[174:175], v[140:141], v[72:73]
    v_pk_fma_f32 v[74:75], v[174:175], v[142:143], v[74:75]
    v_pk_fma_f32 v[76:77], v[174:175], v[144:145], v[76:77]
    v_pk_fma_f32 v[78:79], v[174:175], v[146:147], v[78:79]
    v_max_f32 v64, 0, v64
    v_max_f32 v65, 0, v65
    v_pk_mul_f32 v[72:73], v[178:179], v[72:73]
    v_max_f32 v66, 0, v66
    v_max_f32 v67, 0, v67
    v_pk_mul_f32 v[74:75], v[178:179], v[74:75]
    v_max_f32 v68, 0, v68
    v_max_f32 v69, 0, v69
    v_pk_mul_f32 v[76:77], v[178:179], v[76:77]
    v_max_f32 v70, 0, v70
    v_max_f32 v71, 0, v71
    v_pk_mul_f32 v[78:79], v[178:179], v[78:79]
    v_pk_mul_f32 v[64:65], v[64:65], v[72:73]
    v_pk_mul_f32 v[66:67], v[66:67], v[74:75]
    v_pk_mul_f32 v[68:69], v[68:69], v[76:77]
    v_pk_mul_f32 v[70:71], v[70:71], v[78:79]
    v_cvt_pk_bf16_f32 v218, v64, v65
    v_cvt_pk_bf16_f32 v219, v66, v67
    v_cvt_pk_bf16_f32 v220, v68, v69
    v_cvt_pk_bf16_f32 v221, v70, v71
    buffer_store_dwordx4 v[218:221], v12, s[92:95], s46 offen offset:512 sc1
    s_waitcnt lgkmcnt(0)
    v_pk_fma_f32 v[80:81], v[172:173], v[148:149], v[80:81]
    v_pk_fma_f32 v[82:83], v[172:173], v[150:151], v[82:83]
    v_pk_fma_f32 v[84:85], v[172:173], v[152:153], v[84:85]
    v_pk_fma_f32 v[86:87], v[172:173], v[154:155], v[86:87]
    v_pk_fma_f32 v[88:89], v[172:173], v[156:157], v[88:89]
    v_pk_fma_f32 v[90:91], v[172:173], v[158:159], v[90:91]
    v_pk_fma_f32 v[92:93], v[172:173], v[160:161], v[92:93]
    v_pk_fma_f32 v[94:95], v[172:173], v[162:163], v[94:95]
    v_max_f32 v80, 0, v80
    v_max_f32 v81, 0, v81
    v_pk_mul_f32 v[88:89], v[176:177], v[88:89]
    v_max_f32 v82, 0, v82
    v_max_f32 v83, 0, v83
    v_pk_mul_f32 v[90:91], v[176:177], v[90:91]
    v_max_f32 v84, 0, v84
    v_max_f32 v85, 0, v85
    v_pk_mul_f32 v[92:93], v[176:177], v[92:93]
    v_max_f32 v86, 0, v86
    v_max_f32 v87, 0, v87
    v_pk_mul_f32 v[94:95], v[176:177], v[94:95]
    v_pk_mul_f32 v[80:81], v[80:81], v[88:89]
    v_pk_mul_f32 v[82:83], v[82:83], v[90:91]
    v_pk_mul_f32 v[84:85], v[84:85], v[92:93]
    v_pk_mul_f32 v[86:87], v[86:87], v[94:95]
    v_cvt_pk_bf16_f32 v222, v80, v81
    v_cvt_pk_bf16_f32 v223, v82, v83
    v_cvt_pk_bf16_f32 v224, v84, v85
    v_cvt_pk_bf16_f32 v225, v86, v87
    buffer_store_dwordx4 v[222:225], v12, s[92:95], s43 offen offset:1024 sc1
    v_pk_fma_f32 v[96:97], v[174:175], v[148:149], v[96:97]
    v_pk_fma_f32 v[98:99], v[174:175], v[150:151], v[98:99]
    v_pk_fma_f32 v[100:101], v[174:175], v[152:153], v[100:101]
    v_pk_fma_f32 v[102:103], v[174:175], v[154:155], v[102:103]
    v_pk_fma_f32 v[104:105], v[174:175], v[156:157], v[104:105]
    v_pk_fma_f32 v[106:107], v[174:175], v[158:159], v[106:107]
    v_pk_fma_f32 v[108:109], v[174:175], v[160:161], v[108:109]
    v_pk_fma_f32 v[110:111], v[174:175], v[162:163], v[110:111]
    v_max_f32 v96, 0, v96
    v_max_f32 v97, 0, v97
    v_pk_mul_f32 v[104:105], v[178:179], v[104:105]
    v_max_f32 v98, 0, v98
    v_max_f32 v99, 0, v99
    v_pk_mul_f32 v[106:107], v[178:179], v[106:107]
    v_max_f32 v100, 0, v100
    v_max_f32 v101, 0, v101
    v_pk_mul_f32 v[108:109], v[178:179], v[108:109]
    v_max_f32 v102, 0, v102
    v_max_f32 v103, 0, v103
    v_pk_mul_f32 v[110:111], v[178:179], v[110:111]
    v_pk_mul_f32 v[96:97], v[96:97], v[104:105]
    v_pk_mul_f32 v[98:99], v[98:99], v[106:107]
    v_pk_mul_f32 v[100:101], v[100:101], v[108:109]
    v_pk_mul_f32 v[102:103], v[102:103], v[110:111]
    v_cvt_pk_bf16_f32 v226, v96, v97
    v_cvt_pk_bf16_f32 v227, v98, v99
    v_cvt_pk_bf16_f32 v228, v100, v101
    v_cvt_pk_bf16_f32 v229, v102, v103
    buffer_store_dwordx4 v[226:229], v12, s[92:95], s46 offen offset:1024 sc1
M4_START:
    s_lshr_b32 s10, s7, 1
    s_and_b32 s11, s7, 1
    s_lshl_b32 s8, s6, 1
    s_add_u32 s11, s11, s8

    s_mul_i32 s8, s3, 3
    s_add_u32 s8, s8, 0
    s_lshr_b32 s12, s8, 2
    s_and_b32 s8, s8, 3
    s_mul_i32 s8, s8, 10240
    s_add_u32 s12, s12, 1
    s_cmp_eq_u32 s12, 3
    s_cselect_b32 s12, 0, s12
    s_mul_i32 s12, s12, 41216
    s_add_u32 s8, s8, s12
    v_add_u32 v240, s8, v4

    s_mul_i32 s8, s3, 3
    s_add_u32 s8, s8, 1
    s_lshr_b32 s12, s8, 2
    s_and_b32 s8, s8, 3
    s_mul_i32 s8, s8, 10240
    s_add_u32 s12, s12, 1
    s_cmp_eq_u32 s12, 3
    s_cselect_b32 s12, 0, s12
    s_mul_i32 s12, s12, 41216
    s_add_u32 s8, s8, s12
    v_add_u32 v241, s8, v4

    s_mul_i32 s8, s3, 3
    s_add_u32 s8, s8, 2
    s_lshr_b32 s12, s8, 2
    s_and_b32 s8, s8, 3
    s_mul_i32 s8, s8, 10240
    s_add_u32 s12, s12, 1
    s_cmp_eq_u32 s12, 3
    s_cselect_b32 s12, 0, s12
    s_mul_i32 s12, s12, 41216
    s_add_u32 s8, s8, s12
    v_add_u32 v242, s8, v4

    s_waitcnt vmcnt(0)
    s_barrier
    ds_read_b128 v[86:89], v240 offset:0
    ds_read_b128 v[90:93], v240 offset:1024
    ds_read_b128 v[94:97], v240 offset:2048
    ds_read_b128 v[98:101], v240 offset:3072
    ds_read_b128 v[102:105], v240 offset:4096
    ds_read_b128 v[106:109], v240 offset:5120
    ds_read_b128 v[110:113], v240 offset:6144
    ds_read_b128 v[114:117], v240 offset:7168
    ds_read_b128 v[118:121], v240 offset:8192
    ds_read_b128 v[122:125], v240 offset:9216
    ds_read_b128 v[126:129], v241 offset:0
    ds_read_b128 v[130:133], v241 offset:1024
    ds_read_b128 v[134:137], v241 offset:2048
    ds_read_b128 v[138:141], v241 offset:3072
    ds_read_b128 v[142:145], v241 offset:4096
    ds_read_b128 v[146:149], v241 offset:5120
    ds_read_b128 v[150:153], v241 offset:6144
    ds_read_b128 v[154:157], v241 offset:7168
    ds_read_b128 v[158:161], v241 offset:8192
    ds_read_b128 v[162:165], v241 offset:9216
    ds_read_b128 v[166:169], v242 offset:0
    ds_read_b128 v[170:173], v242 offset:1024
    ds_read_b128 v[174:177], v242 offset:2048
    ds_read_b128 v[178:181], v242 offset:3072
    ds_read_b128 v[182:185], v242 offset:4096
    ds_read_b128 v[186:189], v242 offset:5120
    ds_read_b128 v[190:193], v242 offset:6144
    ds_read_b128 v[194:197], v242 offset:7168
    ds_read_b128 v[198:201], v242 offset:8192
    ds_read_b128 v[202:205], v242 offset:9216
M4_START2:
    v_lshrrev_b32 v5, 3, v2
    v_and_b32 v3, 7, v2
    v_mul_u32_u24 v5, 4096, v5
    v_lshl_add_u32 v5, v3, 4, v5
    s_mul_i32 s8, s10, 327680
    s_lshl_b32 s12, s11, 7
    s_add_u32 s8, s8, s12
    s_mul_i32 s12, s3, 65536
    s_add_u32 s8, s8, s12
    s_add_u32 s8, s8, 8388608
    s_min_u32 s13, s3, 5
    s_lshl_b32 s12, s13, 11
    s_add_u32 m0, s12, 141056
    s_cmp_lt_u32 s3, 5
    s_cselect_b32 s8, s8, 0x40000000
    s_add_u32 s12, s8, 31744
    buffer_load_dwordx4 v5, s[92:95], s8 offen sc1 lds
    buffer_load_dwordx4 v5, s[92:95], s12 offen offset:1024 sc1 lds
    s_mul_i32 s8, s11, 196608
    s_mul_i32 s12, s3, 6144
    s_add_u32 s8, s8, s12
    s_add_u32 s31, s8, 14680064
    s_add_u32 s32, s31, 49152
    s_add_u32 s33, s31, 98304
    s_add_u32 s34, s31, 147456
    s_lshl_b32 s36, s6, 7
    s_add_u32 s35, s36, 8262912
    s_add_u32 s36, s36, 8260864
    s_lshr_b32 s8, s11, 1
    s_lshl_b32 s8, s8, 7
    s_add_u32 s8, s8, 8262912
    v_mov_b32 v3, s8

    s_mov_b32 s20, s84
    s_mov_b32 s21, s85
    s_mov_b32 s22, 2621440
    s_mov_b32 s23, 0x20000
    s_cmp_lt_u32 s3, 4
    s_cbranch_scc1 M4_NOPOLL
    s_waitcnt vmcnt(2)
    s_barrier
    s_cmp_lg_u32 s3, 4
    s_cbranch_scc1 M4_NOPOLL

    v_mov_b32 v248, s36
    v_mov_b32 v249, 1
    s_mov_b64 exec, 1
    buffer_atomic_add v249, v248, s[92:95], 0 offen sc0 sc1
    s_waitcnt vmcnt(0)
    v_readfirstlane_b32 s4, v249
    s_mov_b64 exec, -1
    s_and_b32 s4, s4, 15
    s_cmp_lg_u32 s4, 15
    s_cbranch_scc1 ARR_27

    v_mov_b32 v251, 1
    v_lshlrev_b32 v250, 7, v0
    v_add_u32 v250, s35, v250

    s_mov_b64 exec, 0x1
    buffer_store_dword v251, v250, s[92:95], 0 offen sc1
    s_mov_b64 exec, -1
ARR_27:
    s_mov_b64 exec, 1
    s_mov_b32 s4, 0
POLL_28:
    buffer_load_dword v252, v3, s[92:95], 0 offen sc1
    s_add_u32 s4, s4, 1
    s_waitcnt vmcnt(0)
    v_cmp_gt_u32 vcc, 1, v252
    s_cmp_gt_u32 s4, 0x40000
    s_cbranch_scc1 POLL_28_x

    s_cbranch_vccnz POLL_28
POLL_28_x:
    s_mov_b64 exec, -1

M4_NOPOLL:
    s_waitcnt lgkmcnt(0)
    s_barrier
    buffer_load_dwordx4 v[206:209], v4, s[92:95], s31 offen offset:0 sc1
    buffer_load_dwordx4 v[210:213], v4, s[92:95], s32 offen offset:0 sc1
    buffer_load_dwordx4 v[214:217], v4, s[92:95], s33 offen offset:0 sc1
    buffer_load_dwordx4 v[218:221], v4, s[92:95], s34 offen offset:0 sc1
    buffer_load_dwordx4 v[222:225], v4, s[92:95], s31 offen offset:1024 sc1
    buffer_load_dwordx4 v[226:229], v4, s[92:95], s32 offen offset:1024 sc1
    buffer_load_dwordx4 v[230:233], v4, s[92:95], s33 offen offset:1024 sc1
    buffer_load_dwordx4 v[234:237], v4, s[92:95], s34 offen offset:1024 sc1
    buffer_load_dwordx4 v[238:241], v4, s[92:95], s31 offen offset:2048 sc1
    buffer_load_dwordx4 v[242:245], v4, s[92:95], s32 offen offset:2048 sc1
    buffer_load_dwordx4 v[246:249], v4, s[92:95], s33 offen offset:2048 sc1
    buffer_load_dwordx4 v[250:253], v4, s[92:95], s34 offen offset:2048 sc1
    s_mul_i32 s8, s3, 12288
    v_add_u32 v1, 3072, v4
    v_add_u32 v3, s8, v4
    s_add_u32 m0, s8, 0
    s_nop 0
    buffer_load_dwordx4 v1, s[92:95], s31 offen offset:0 sc1 lds
    buffer_load_dwordx4 v1, s[92:95], s31 offen offset:1024 sc1 lds
    buffer_load_dwordx4 v1, s[92:95], s31 offen offset:2048 sc1 lds
    s_add_u32 m0, s8, 3072
    s_nop 0
    buffer_load_dwordx4 v1, s[92:95], s32 offen offset:0 sc1 lds
    buffer_load_dwordx4 v1, s[92:95], s32 offen offset:1024 sc1 lds
    buffer_load_dwordx4 v1, s[92:95], s32 offen offset:2048 sc1 lds
    s_add_u32 m0, s8, 6144
    s_nop 0
    buffer_load_dwordx4 v1, s[92:95], s33 offen offset:0 sc1 lds
    buffer_load_dwordx4 v1, s[92:95], s33 offen offset:1024 sc1 lds
    buffer_load_dwordx4 v1, s[92:95], s33 offen offset:2048 sc1 lds
    s_add_u32 m0, s8, 9216
    s_nop 0
    buffer_load_dwordx4 v1, s[92:95], s34 offen offset:0 sc1 lds
    buffer_load_dwordx4 v1, s[92:95], s34 offen offset:1024 sc1 lds
    buffer_load_dwordx4 v1, s[92:95], s34 offen offset:2048 sc1 lds
    s_waitcnt vmcnt(20)
    v_mfma_f32_16x16x32_bf16 v[6:9], v[86:89], v[206:209], 0
    v_mfma_f32_16x16x32_bf16 v[10:13], v[86:89], v[210:213], 0
    v_mfma_f32_16x16x32_bf16 v[14:17], v[86:89], v[214:217], 0
    v_mfma_f32_16x16x32_bf16 v[18:21], v[86:89], v[218:221], 0
    v_mfma_f32_16x16x32_bf16 v[22:25], v[90:93], v[206:209], 0
    v_mfma_f32_16x16x32_bf16 v[26:29], v[90:93], v[210:213], 0
    v_mfma_f32_16x16x32_bf16 v[30:33], v[90:93], v[214:217], 0
    v_mfma_f32_16x16x32_bf16 v[34:37], v[90:93], v[218:221], 0
    v_mfma_f32_16x16x32_bf16 v[38:41], v[94:97], v[206:209], 0
    v_mfma_f32_16x16x32_bf16 v[42:45], v[94:97], v[210:213], 0
    v_mfma_f32_16x16x32_bf16 v[46:49], v[94:97], v[214:217], 0
    v_mfma_f32_16x16x32_bf16 v[50:53], v[94:97], v[218:221], 0
    v_mfma_f32_16x16x32_bf16 v[54:57], v[98:101], v[206:209], 0
    v_mfma_f32_16x16x32_bf16 v[58:61], v[98:101], v[210:213], 0
    v_mfma_f32_16x16x32_bf16 v[62:65], v[98:101], v[214:217], 0
    v_mfma_f32_16x16x32_bf16 v[66:69], v[98:101], v[218:221], 0
    v_mfma_f32_16x16x32_bf16 v[70:73], v[102:105], v[206:209], 0
    v_mfma_f32_16x16x32_bf16 v[74:77], v[102:105], v[210:213], 0
    v_mfma_f32_16x16x32_bf16 v[78:81], v[102:105], v[214:217], 0
    v_mfma_f32_16x16x32_bf16 v[82:85], v[102:105], v[218:221], 0
    s_waitcnt vmcnt(16)
    v_mfma_f32_16x16x32_bf16 v[6:9], v[106:109], v[222:225], v[6:9]
    v_mfma_f32_16x16x32_bf16 v[10:13], v[106:109], v[226:229], v[10:13]
    v_mfma_f32_16x16x32_bf16 v[14:17], v[106:109], v[230:233], v[14:17]
    v_mfma_f32_16x16x32_bf16 v[18:21], v[106:109], v[234:237], v[18:21]
    v_mfma_f32_16x16x32_bf16 v[22:25], v[110:113], v[222:225], v[22:25]
    v_mfma_f32_16x16x32_bf16 v[26:29], v[110:113], v[226:229], v[26:29]
    v_mfma_f32_16x16x32_bf16 v[30:33], v[110:113], v[230:233], v[30:33]
    v_mfma_f32_16x16x32_bf16 v[34:37], v[110:113], v[234:237], v[34:37]
    v_mfma_f32_16x16x32_bf16 v[38:41], v[114:117], v[222:225], v[38:41]
    v_mfma_f32_16x16x32_bf16 v[42:45], v[114:117], v[226:229], v[42:45]
    v_mfma_f32_16x16x32_bf16 v[46:49], v[114:117], v[230:233], v[46:49]
    v_mfma_f32_16x16x32_bf16 v[50:53], v[114:117], v[234:237], v[50:53]
    v_mfma_f32_16x16x32_bf16 v[54:57], v[118:121], v[222:225], v[54:57]
    v_mfma_f32_16x16x32_bf16 v[58:61], v[118:121], v[226:229], v[58:61]
    v_mfma_f32_16x16x32_bf16 v[62:65], v[118:121], v[230:233], v[62:65]
    v_mfma_f32_16x16x32_bf16 v[66:69], v[118:121], v[234:237], v[66:69]
    v_mfma_f32_16x16x32_bf16 v[70:73], v[122:125], v[222:225], v[70:73]
    v_mfma_f32_16x16x32_bf16 v[74:77], v[122:125], v[226:229], v[74:77]
    v_mfma_f32_16x16x32_bf16 v[78:81], v[122:125], v[230:233], v[78:81]
    v_mfma_f32_16x16x32_bf16 v[82:85], v[122:125], v[234:237], v[82:85]
    s_waitcnt vmcnt(12)
    v_mfma_f32_16x16x32_bf16 v[6:9], v[126:129], v[238:241], v[6:9]
    v_mfma_f32_16x16x32_bf16 v[10:13], v[126:129], v[242:245], v[10:13]
    v_mfma_f32_16x16x32_bf16 v[14:17], v[126:129], v[246:249], v[14:17]
    v_mfma_f32_16x16x32_bf16 v[18:21], v[126:129], v[250:253], v[18:21]
    v_mfma_f32_16x16x32_bf16 v[22:25], v[130:133], v[238:241], v[22:25]
    v_mfma_f32_16x16x32_bf16 v[26:29], v[130:133], v[242:245], v[26:29]
    v_mfma_f32_16x16x32_bf16 v[30:33], v[130:133], v[246:249], v[30:33]
    v_mfma_f32_16x16x32_bf16 v[34:37], v[130:133], v[250:253], v[34:37]
    v_mfma_f32_16x16x32_bf16 v[38:41], v[134:137], v[238:241], v[38:41]
    v_mfma_f32_16x16x32_bf16 v[42:45], v[134:137], v[242:245], v[42:45]
    v_mfma_f32_16x16x32_bf16 v[46:49], v[134:137], v[246:249], v[46:49]
    v_mfma_f32_16x16x32_bf16 v[50:53], v[134:137], v[250:253], v[50:53]
    v_mfma_f32_16x16x32_bf16 v[54:57], v[138:141], v[238:241], v[54:57]
    v_mfma_f32_16x16x32_bf16 v[58:61], v[138:141], v[242:245], v[58:61]
    v_mfma_f32_16x16x32_bf16 v[62:65], v[138:141], v[246:249], v[62:65]
    v_mfma_f32_16x16x32_bf16 v[66:69], v[138:141], v[250:253], v[66:69]
    v_mfma_f32_16x16x32_bf16 v[70:73], v[142:145], v[238:241], v[70:73]
    v_mfma_f32_16x16x32_bf16 v[74:77], v[142:145], v[242:245], v[74:77]
    v_mfma_f32_16x16x32_bf16 v[78:81], v[142:145], v[246:249], v[78:81]
    v_mfma_f32_16x16x32_bf16 v[82:85], v[142:145], v[250:253], v[82:85]
    s_waitcnt vmcnt(0)
    ds_read_b128 v[206:209], v3 offset:0
    ds_read_b128 v[210:213], v3 offset:3072
    ds_read_b128 v[214:217], v3 offset:6144
    ds_read_b128 v[218:221], v3 offset:9216
    ds_read_b128 v[222:225], v3 offset:1024
    ds_read_b128 v[226:229], v3 offset:4096
    ds_read_b128 v[230:233], v3 offset:7168
    ds_read_b128 v[234:237], v3 offset:10240
    ds_read_b128 v[238:241], v3 offset:2048
    ds_read_b128 v[242:245], v3 offset:5120
    ds_read_b128 v[246:249], v3 offset:8192
    ds_read_b128 v[250:253], v3 offset:11264
    s_waitcnt lgkmcnt(8)
    v_mfma_f32_16x16x32_bf16 v[6:9], v[146:149], v[206:209], v[6:9]
    v_mfma_f32_16x16x32_bf16 v[10:13], v[146:149], v[210:213], v[10:13]
    v_mfma_f32_16x16x32_bf16 v[14:17], v[146:149], v[214:217], v[14:17]
    v_mfma_f32_16x16x32_bf16 v[18:21], v[146:149], v[218:221], v[18:21]
    v_mfma_f32_16x16x32_bf16 v[22:25], v[150:153], v[206:209], v[22:25]
    v_mfma_f32_16x16x32_bf16 v[26:29], v[150:153], v[210:213], v[26:29]
    v_mfma_f32_16x16x32_bf16 v[30:33], v[150:153], v[214:217], v[30:33]
    v_mfma_f32_16x16x32_bf16 v[34:37], v[150:153], v[218:221], v[34:37]
    v_mfma_f32_16x16x32_bf16 v[38:41], v[154:157], v[206:209], v[38:41]
    v_mfma_f32_16x16x32_bf16 v[42:45], v[154:157], v[210:213], v[42:45]
    v_mfma_f32_16x16x32_bf16 v[46:49], v[154:157], v[214:217], v[46:49]
    v_mfma_f32_16x16x32_bf16 v[50:53], v[154:157], v[218:221], v[50:53]
    v_mfma_f32_16x16x32_bf16 v[54:57], v[158:161], v[206:209], v[54:57]
    v_mfma_f32_16x16x32_bf16 v[58:61], v[158:161], v[210:213], v[58:61]
    v_mfma_f32_16x16x32_bf16 v[62:65], v[158:161], v[214:217], v[62:65]
    v_mfma_f32_16x16x32_bf16 v[66:69], v[158:161], v[218:221], v[66:69]
    v_mfma_f32_16x16x32_bf16 v[70:73], v[162:165], v[206:209], v[70:73]
    v_mfma_f32_16x16x32_bf16 v[74:77], v[162:165], v[210:213], v[74:77]
    v_mfma_f32_16x16x32_bf16 v[78:81], v[162:165], v[214:217], v[78:81]
    v_mfma_f32_16x16x32_bf16 v[82:85], v[162:165], v[218:221], v[82:85]
    s_waitcnt lgkmcnt(4)
    v_mfma_f32_16x16x32_bf16 v[6:9], v[166:169], v[222:225], v[6:9]
    v_mfma_f32_16x16x32_bf16 v[10:13], v[166:169], v[226:229], v[10:13]
    v_mfma_f32_16x16x32_bf16 v[14:17], v[166:169], v[230:233], v[14:17]
    v_mfma_f32_16x16x32_bf16 v[18:21], v[166:169], v[234:237], v[18:21]
    v_mfma_f32_16x16x32_bf16 v[22:25], v[170:173], v[222:225], v[22:25]
    v_mfma_f32_16x16x32_bf16 v[26:29], v[170:173], v[226:229], v[26:29]
    v_mfma_f32_16x16x32_bf16 v[30:33], v[170:173], v[230:233], v[30:33]
    v_mfma_f32_16x16x32_bf16 v[34:37], v[170:173], v[234:237], v[34:37]
    v_mfma_f32_16x16x32_bf16 v[38:41], v[174:177], v[222:225], v[38:41]
    v_mfma_f32_16x16x32_bf16 v[42:45], v[174:177], v[226:229], v[42:45]
    v_mfma_f32_16x16x32_bf16 v[46:49], v[174:177], v[230:233], v[46:49]
    v_mfma_f32_16x16x32_bf16 v[50:53], v[174:177], v[234:237], v[50:53]
    v_mfma_f32_16x16x32_bf16 v[54:57], v[178:181], v[222:225], v[54:57]
    v_mfma_f32_16x16x32_bf16 v[58:61], v[178:181], v[226:229], v[58:61]
    v_mfma_f32_16x16x32_bf16 v[62:65], v[178:181], v[230:233], v[62:65]
    v_mfma_f32_16x16x32_bf16 v[66:69], v[178:181], v[234:237], v[66:69]
    v_mfma_f32_16x16x32_bf16 v[70:73], v[182:185], v[222:225], v[70:73]
    v_mfma_f32_16x16x32_bf16 v[74:77], v[182:185], v[226:229], v[74:77]
    v_mfma_f32_16x16x32_bf16 v[78:81], v[182:185], v[230:233], v[78:81]
    v_mfma_f32_16x16x32_bf16 v[82:85], v[182:185], v[234:237], v[82:85]
    v_lshlrev_b32 v5, 3, v2
    v_add_u32 v3, s8, v5
    s_waitcnt lgkmcnt(0)

    v_mfma_f32_16x16x32_bf16 v[6:9], v[186:189], v[238:241], v[6:9]
    v_mfma_f32_16x16x32_bf16 v[10:13], v[186:189], v[242:245], v[10:13]
    v_mfma_f32_16x16x32_bf16 v[14:17], v[186:189], v[246:249], v[14:17]
    v_mfma_f32_16x16x32_bf16 v[18:21], v[186:189], v[250:253], v[18:21]
    v_mfma_f32_16x16x32_bf16 v[22:25], v[190:193], v[238:241], v[22:25]
    v_mfma_f32_16x16x32_bf16 v[26:29], v[190:193], v[242:245], v[26:29]
    v_mfma_f32_16x16x32_bf16 v[30:33], v[190:193], v[246:249], v[30:33]
    v_mfma_f32_16x16x32_bf16 v[34:37], v[190:193], v[250:253], v[34:37]
    v_mfma_f32_16x16x32_bf16 v[38:41], v[194:197], v[238:241], v[38:41]
    v_cvt_pk_bf16_f32 v86, v6, v7
    v_cvt_pk_bf16_f32 v87, v8, v9
    ds_write_b64 v3, v[86:87] offset:0
    v_mfma_f32_16x16x32_bf16 v[42:45], v[194:197], v[242:245], v[42:45]
    v_cvt_pk_bf16_f32 v88, v10, v11
    v_cvt_pk_bf16_f32 v89, v12, v13
    ds_write_b64 v3, v[88:89] offset:512
    v_mfma_f32_16x16x32_bf16 v[46:49], v[194:197], v[246:249], v[46:49]
    v_cvt_pk_bf16_f32 v90, v14, v15
    v_cvt_pk_bf16_f32 v91, v16, v17
    ds_write_b64 v3, v[90:91] offset:1024
    v_mfma_f32_16x16x32_bf16 v[50:53], v[194:197], v[250:253], v[50:53]
    v_cvt_pk_bf16_f32 v92, v18, v19
    v_cvt_pk_bf16_f32 v93, v20, v21
    ds_write_b64 v3, v[92:93] offset:1536
    v_mfma_f32_16x16x32_bf16 v[54:57], v[198:201], v[238:241], v[54:57]
    v_cvt_pk_bf16_f32 v94, v22, v23
    v_cvt_pk_bf16_f32 v95, v24, v25
    ds_write_b64 v3, v[94:95] offset:2048
    v_mfma_f32_16x16x32_bf16 v[58:61], v[198:201], v[242:245], v[58:61]
    v_cvt_pk_bf16_f32 v96, v26, v27
    v_cvt_pk_bf16_f32 v97, v28, v29
    ds_write_b64 v3, v[96:97] offset:2560
    v_mfma_f32_16x16x32_bf16 v[62:65], v[198:201], v[246:249], v[62:65]
    v_cvt_pk_bf16_f32 v98, v30, v31
    v_cvt_pk_bf16_f32 v99, v32, v33
    ds_write_b64 v3, v[98:99] offset:3072
    v_mfma_f32_16x16x32_bf16 v[66:69], v[198:201], v[250:253], v[66:69]
    v_cvt_pk_bf16_f32 v100, v34, v35
    v_cvt_pk_bf16_f32 v101, v36, v37
    ds_write_b64 v3, v[100:101] offset:3584
    v_mfma_f32_16x16x32_bf16 v[70:73], v[202:205], v[238:241], v[70:73]
    v_cvt_pk_bf16_f32 v102, v38, v39
    v_cvt_pk_bf16_f32 v103, v40, v41
    ds_write_b64 v3, v[102:103] offset:4096
    v_mfma_f32_16x16x32_bf16 v[74:77], v[202:205], v[242:245], v[74:77]
    v_cvt_pk_bf16_f32 v104, v42, v43
    v_cvt_pk_bf16_f32 v105, v44, v45
    ds_write_b64 v3, v[104:105] offset:4608
    v_mfma_f32_16x16x32_bf16 v[78:81], v[202:205], v[246:249], v[78:81]
    v_cvt_pk_bf16_f32 v106, v46, v47
    v_cvt_pk_bf16_f32 v107, v48, v49
    ds_write_b64 v3, v[106:107] offset:5120
    v_mfma_f32_16x16x32_bf16 v[82:85], v[202:205], v[250:253], v[82:85]
    v_cvt_pk_bf16_f32 v108, v50, v51
    v_cvt_pk_bf16_f32 v109, v52, v53
    ds_write_b64 v3, v[108:109] offset:5632
    v_cvt_pk_bf16_f32 v110, v54, v55
    v_cvt_pk_bf16_f32 v111, v56, v57
    ds_write_b64 v3, v[110:111] offset:6144
    v_cvt_pk_bf16_f32 v112, v58, v59
    v_cvt_pk_bf16_f32 v113, v60, v61
    ds_write_b64 v3, v[112:113] offset:6656
    v_cvt_pk_bf16_f32 v114, v62, v63
    v_cvt_pk_bf16_f32 v115, v64, v65
    ds_write_b64 v3, v[114:115] offset:7168
    v_cvt_pk_bf16_f32 v116, v66, v67
    v_cvt_pk_bf16_f32 v117, v68, v69
    ds_write_b64 v3, v[116:117] offset:7680
    v_cvt_pk_bf16_f32 v118, v70, v71
    v_cvt_pk_bf16_f32 v119, v72, v73
    ds_write_b64 v3, v[118:119] offset:8192
    v_cvt_pk_bf16_f32 v120, v74, v75
    v_cvt_pk_bf16_f32 v121, v76, v77
    ds_write_b64 v3, v[120:121] offset:8704
    v_cvt_pk_bf16_f32 v122, v78, v79
    v_cvt_pk_bf16_f32 v123, v80, v81
    ds_write_b64 v3, v[122:123] offset:9216
    v_cvt_pk_bf16_f32 v124, v82, v83
    v_cvt_pk_bf16_f32 v125, v84, v85
    ds_write_b64 v3, v[124:125] offset:9728
    s_lshl_b32 s8, s3, 9
    v_add_u32 v5, s8, v5
    v_add_u32 v1, 49152, v5
    v_lshrrev_b32 v6, 4, v2
    v_bfe_u32 v7, v2, 2, 2
    v_lshl_add_u32 v6, v6, 2, v7
    v_lshlrev_b32 v6, 7, v6
    v_and_b32 v7, 3, v2
    v_lshl_add_u32 v6, v7, 3, v6
    s_and_b32 s12, s3, 3
    s_lshr_b32 s13, s3, 2
    s_lshl_b32 s8, s12, 5
    s_lshl_b32 s14, s13, 11
    s_add_u32 s8, s8, s14
    s_add_u32 s8, s8, 141056
    v_add_u32 v6, s8, v6
    v_and_b32 v7, 15, v2
    v_mul_u32_u24 v7, 1280, v7
    v_lshrrev_b32 v8, 4, v2
    v_lshl_add_u32 v7, v8, 3, v7
    s_lshl_b32 s8, s11, 6
    s_lshl_b32 s14, s12, 4
    s_add_u32 s8, s8, s14
    s_mul_i32 s8, s8, 1280
    s_mul_i32 s14, s10, 160
    s_add_u32 s8, s8, s14
    s_lshl_b32 s14, s13, 5
    s_add_u32 s8, s8, s14
    s_cmp_lt_u32 s3, 4
    s_cselect_b32 s15, s8, 0x40000000
    s_waitcnt vmcnt(0) lgkmcnt(0)
    s_barrier

    ds_read_b64 v[130:131], v5 offset:0
    ds_read_b64 v[132:133], v5 offset:12288
    ds_read_b64 v[134:135], v5 offset:24576
    ds_read_b64 v[136:137], v5 offset:36864
    ds_read_b64 v[138:139], v1 offset:0
    ds_read_b64 v[140:141], v1 offset:12288
    ds_read_b64 v[142:143], v1 offset:24576
    ds_read_b64 v[144:145], v1 offset:36864
    ds_read_b64_tr_b16 v[178:179], v6 offset:0
    ds_read_b64 v[146:147], v5 offset:4096
    ds_read_b64 v[148:149], v5 offset:16384
    ds_read_b64 v[150:151], v5 offset:28672
    ds_read_b64 v[152:153], v5 offset:40960
    ds_read_b64 v[154:155], v1 offset:4096
    ds_read_b64 v[156:157], v1 offset:16384
    ds_read_b64 v[158:159], v1 offset:28672
    ds_read_b64 v[160:161], v1 offset:40960
    ds_read_b64_tr_b16 v[180:181], v6 offset:4096
    ds_read_b64 v[162:163], v5 offset:8192
    ds_read_b64 v[164:165], v5 offset:20480
    ds_read_b64 v[166:167], v5 offset:32768
    ds_read_b64 v[168:169], v5 offset:45056
    ds_read_b64 v[170:171], v1 offset:8192
    ds_read_b64 v[172:173], v1 offset:20480
    ds_read_b64 v[174:175], v1 offset:32768
    ds_read_b64 v[176:177], v1 offset:45056
    ds_read_b64_tr_b16 v[182:183], v6 offset:8192
    s_mov_b32 s16, 0x00003f80
    s_mov_b32 s17, 0x3f800000
    s_waitcnt lgkmcnt(15)
    v_lshlrev_b32 v10, 16, v178
    v_and_b32 v11, s40, v178
    v_lshlrev_b32 v12, 16, v179
    v_and_b32 v13, s40, v179

    v_dot2_f32_bf16 v10, v130, s16, v10
    v_dot2_f32_bf16 v11, v130, s17, v11
    v_dot2_f32_bf16 v12, v131, s16, v12
    v_dot2_f32_bf16 v13, v131, s17, v13

    v_dot2_f32_bf16 v10, v132, s16, v10
    v_dot2_f32_bf16 v11, v132, s17, v11
    v_dot2_f32_bf16 v12, v133, s16, v12
    v_dot2_f32_bf16 v13, v133, s17, v13

    v_dot2_f32_bf16 v10, v134, s16, v10
    v_dot2_f32_bf16 v11, v134, s17, v11
    v_dot2_f32_bf16 v12, v135, s16, v12
    v_dot2_f32_bf16 v13, v135, s17, v13

    v_dot2_f32_bf16 v10, v136, s16, v10
    v_dot2_f32_bf16 v11, v136, s17, v11
    v_dot2_f32_bf16 v12, v137, s16, v12
    v_dot2_f32_bf16 v13, v137, s17, v13

    v_dot2_f32_bf16 v10, v138, s16, v10
    v_dot2_f32_bf16 v11, v138, s17, v11
    v_dot2_f32_bf16 v12, v139, s16, v12
    v_dot2_f32_bf16 v13, v139, s17, v13

    v_dot2_f32_bf16 v10, v140, s16, v10
    v_dot2_f32_bf16 v11, v140, s17, v11
    v_dot2_f32_bf16 v12, v141, s16, v12
    v_dot2_f32_bf16 v13, v141, s17, v13

    v_dot2_f32_bf16 v10, v142, s16, v10
    v_dot2_f32_bf16 v11, v142, s17, v11
    v_dot2_f32_bf16 v12, v143, s16, v12
    v_dot2_f32_bf16 v13, v143, s17, v13

    v_dot2_f32_bf16 v10, v144, s16, v10
    v_dot2_f32_bf16 v11, v144, s17, v11
    v_dot2_f32_bf16 v12, v145, s16, v12
    v_dot2_f32_bf16 v13, v145, s17, v13

    s_nop 2
    v_cvt_pk_bf16_f32 v22, v10, v11
    v_cvt_pk_bf16_f32 v23, v12, v13
    buffer_store_dwordx2 v[22:23], v7, s[20:23], s8 offen offset:0

    s_waitcnt lgkmcnt(9)
    v_lshlrev_b32 v26, 16, v180
    v_and_b32 v27, s40, v180
    v_lshlrev_b32 v28, 16, v181
    v_and_b32 v29, s40, v181

    v_dot2_f32_bf16 v26, v146, s16, v26
    v_dot2_f32_bf16 v27, v146, s17, v27
    v_dot2_f32_bf16 v28, v147, s16, v28
    v_dot2_f32_bf16 v29, v147, s17, v29

    v_dot2_f32_bf16 v26, v148, s16, v26
    v_dot2_f32_bf16 v27, v148, s17, v27
    v_dot2_f32_bf16 v28, v149, s16, v28
    v_dot2_f32_bf16 v29, v149, s17, v29

    v_dot2_f32_bf16 v26, v150, s16, v26
    v_dot2_f32_bf16 v27, v150, s17, v27
    v_dot2_f32_bf16 v28, v151, s16, v28
    v_dot2_f32_bf16 v29, v151, s17, v29

    v_dot2_f32_bf16 v26, v152, s16, v26
    v_dot2_f32_bf16 v27, v152, s17, v27
    v_dot2_f32_bf16 v28, v153, s16, v28
    v_dot2_f32_bf16 v29, v153, s17, v29

    v_dot2_f32_bf16 v26, v154, s16, v26
    v_dot2_f32_bf16 v27, v154, s17, v27
    v_dot2_f32_bf16 v28, v155, s16, v28
    v_dot2_f32_bf16 v29, v155, s17, v29

    v_dot2_f32_bf16 v26, v156, s16, v26
    v_dot2_f32_bf16 v27, v156, s17, v27
    v_dot2_f32_bf16 v28, v157, s16, v28
    v_dot2_f32_bf16 v29, v157, s17, v29

    v_dot2_f32_bf16 v26, v158, s16, v26
    v_dot2_f32_bf16 v27, v158, s17, v27
    v_dot2_f32_bf16 v28, v159, s16, v28
    v_dot2_f32_bf16 v29, v159, s17, v29

    v_dot2_f32_bf16 v26, v160, s16, v26
    v_dot2_f32_bf16 v27, v160, s17, v27
    v_dot2_f32_bf16 v28, v161, s16, v28
    v_dot2_f32_bf16 v29, v161, s17, v29

    s_nop 2
    v_cvt_pk_bf16_f32 v38, v26, v27
    v_cvt_pk_bf16_f32 v39, v28, v29
    buffer_store_dwordx2 v[38:39], v7, s[20:23], s8 offen offset:64

    s_cmp_ge_u32 s3, 4
    s_cbranch_scc1 M4_DONE
    s_waitcnt lgkmcnt(0)
    v_lshlrev_b32 v42, 16, v182
    v_and_b32 v43, s40, v182
    v_lshlrev_b32 v44, 16, v183
    v_and_b32 v45, s40, v183

    v_dot2_f32_bf16 v42, v162, s16, v42
    v_dot2_f32_bf16 v43, v162, s17, v43
    v_dot2_f32_bf16 v44, v163, s16, v44
    v_dot2_f32_bf16 v45, v163, s17, v45

    v_dot2_f32_bf16 v42, v164, s16, v42
    v_dot2_f32_bf16 v43, v164, s17, v43
    v_dot2_f32_bf16 v44, v165, s16, v44
    v_dot2_f32_bf16 v45, v165, s17, v45

    v_dot2_f32_bf16 v42, v166, s16, v42
    v_dot2_f32_bf16 v43, v166, s17, v43
    v_dot2_f32_bf16 v44, v167, s16, v44
    v_dot2_f32_bf16 v45, v167, s17, v45

    v_dot2_f32_bf16 v42, v168, s16, v42
    v_dot2_f32_bf16 v43, v168, s17, v43
    v_dot2_f32_bf16 v44, v169, s16, v44
    v_dot2_f32_bf16 v45, v169, s17, v45

    v_dot2_f32_bf16 v42, v170, s16, v42
    v_dot2_f32_bf16 v43, v170, s17, v43
    v_dot2_f32_bf16 v44, v171, s16, v44
    v_dot2_f32_bf16 v45, v171, s17, v45

    v_dot2_f32_bf16 v42, v172, s16, v42
    v_dot2_f32_bf16 v43, v172, s17, v43
    v_dot2_f32_bf16 v44, v173, s16, v44
    v_dot2_f32_bf16 v45, v173, s17, v45

    v_dot2_f32_bf16 v42, v174, s16, v42
    v_dot2_f32_bf16 v43, v174, s17, v43
    v_dot2_f32_bf16 v44, v175, s16, v44
    v_dot2_f32_bf16 v45, v175, s17, v45

    v_dot2_f32_bf16 v42, v176, s16, v42
    v_dot2_f32_bf16 v43, v176, s17, v43
    v_dot2_f32_bf16 v44, v177, s16, v44
    v_dot2_f32_bf16 v45, v177, s17, v45

    s_nop 2
    v_cvt_pk_bf16_f32 v54, v42, v43
    v_cvt_pk_bf16_f32 v55, v44, v45
    buffer_store_dwordx2 v[54:55], v7, s[20:23], s15 offen offset:128

M4_DONE:
M_END:
    s_endpgm
M_CODE_END:
.section .rodata,"a"
.p2align 6
.amdhsa_kernel sequential_preLN__ssm_conv_h3__glu_gated_reglu__prompt_kernel
  .amdhsa_next_free_vgpr 256
  .amdhsa_next_free_sgpr 102
  .amdhsa_accum_offset 256
  .amdhsa_group_segment_fixed_size 0
  .amdhsa_kernarg_size 104
  .amdhsa_user_sgpr_count 2
  .amdhsa_user_sgpr_kernarg_segment_ptr 1
  .amdhsa_system_sgpr_workgroup_id_x 1
  .amdhsa_float_denorm_mode_32 3
.end_amdhsa_kernel
```
